```python
import torch

def _softmax(x, axis=-1):
    return torch.softmax(x, dim=axis)
def _gelu(x):
    return torch.nn.functional.gelu(x, approximate="tanh")
def _silu(x):
    return torch.nn.functional.silu(x)
def _sigmoid(x):
    return torch.sigmoid(x)
def _layernorm(x, axis=-1, eps=1e-5):
    m = x.mean(dim=axis, keepdim=True)
    v = x.var(dim=axis, keepdim=True, unbiased=False)
    return (x - m) / torch.sqrt(v + eps)
def _scatter_add(tgt, idx, src, axis=0):
    return tgt.clone().index_add_(axis, idx, src)
def _segment_sum(src, seg, n):
    out = torch.zeros((n,) + src.shape[1:], dtype=src.dtype)
    return out.index_add_(0, seg, src)
def _pad(x, pw):
    flat = tuple(v for pair in reversed(pw) for v in pair)
    return torch.nn.functional.pad(x, flat)

kernel_name = 'standalone__mha_block_cached__near_ridge'

def setup_inputs():

    _w = (lambda a: (lambda t: t.to(torch.bfloat16) if t.is_floating_point() else t)(torch.as_tensor(a)))
    B, Sq, D = 32, 144, 512
    H, Sk, Dh = 32, 512, 128
    return {
        "x": _w((lambda *s: torch.randn(*s, dtype=torch.bfloat16) * 0.8)(B, Sq, D)),
        "k_cache": _w((lambda *s: torch.randn(*s, dtype=torch.bfloat16) * 0.8)(B, H, Sk, Dh)),
        "v_cache": _w((lambda *s: torch.randn(*s, dtype=torch.bfloat16) * 0.05)(B, H, Sk, Dh)),
        "wq": _w((lambda *s: torch.randn(*s, dtype=torch.bfloat16) * 0.8)(D, H * Dh) * (D ** -0.5)),
        "wo": _w((lambda *s: torch.randn(*s, dtype=torch.bfloat16) * 0.05)(H * Dh, D) * ((H * Dh) ** -0.5)),
    }

def reference(x, k_cache, v_cache, wq, wo):
    B, Sq, D = x.shape
    H, Dh = 32, 128
    q = (lambda x, *d: x.permute(*d))((x @ wq).reshape(B, Sq, H, Dh), 0, 2, 1, 3)
    scores = torch.einsum("bhqd,bhkd->bhqk", q, k_cache) * (Dh ** -0.5)
    p = _softmax(scores, axis=-1)
    o = torch.einsum("bhqk,bhkd->bhqd", p, v_cache)
    return (lambda x, *d: x.permute(*d))(o, 0, 2, 1, 3).reshape(B, Sq, H * Dh) @ wo
```

```asm
; @launch kernel=attn_kernel grid=(1024,1,1) block=(192,1,1) lds=77824
; @launch kernel=oproj_kernel grid=(256,1,1) block=(256,1,1) lds=159744
.amdgcn_target "amdgcn-amd-amdhsa--gfx950"
.text
.globl attn_kernel
.p2align 8
.type attn_kernel,@function
attn_kernel:
    s_cmp_ge_u32 s2, 1024
    s_cbranch_scc1 attn_done
    s_load_dwordx4 s[4:7], s[0:1], 0
    s_load_dwordx4 s[8:11], s[0:1], 16
    s_load_dwordx2 s[12:13], s[0:1], 56
    v_and_b32 v1, 63, v0
    v_lshrrev_b32 v9, 6, v0
    v_and_b32 v2, 15, v1
    v_lshrrev_b32 v3, 4, v1
    s_nop 0
    v_readfirstlane_b32 s3, v9
    s_lshr_b32 s14, s2, 5
    s_and_b32 s15, s2, 31
    s_waitcnt lgkmcnt(0)
    s_lshl_b32 s20, s2, 17
    s_add_u32 s16, s6, s20
    s_addc_u32 s17, s7, 0
    s_and_b32 s17, s17, 0xffff
    s_mov_b32 s18, 0x20000
    s_mov_b32 s19, 0x20000
    s_lshl_b32 s24, s2, 17
    s_add_u32 s20, s8, s24
    s_addc_u32 s21, s9, 0
    s_and_b32 s21, s21, 0xffff
    s_mov_b32 s22, 0x20000
    s_mov_b32 s23, 0x20000
    s_lshl_b32 s28, s15, 8
    s_add_u32 s24, s10, s28
    s_addc_u32 s25, s11, 0
    s_and_b32 s25, s25, 0xffff
    s_sub_u32 s26, 0x400000, s28
    s_mov_b32 s27, 0x20000
    s_mul_i32 s32, s14, 147456
    s_add_u32 s28, s4, s32
    s_addc_u32 s29, s5, 0
    s_and_b32 s29, s29, 0xffff
    s_mov_b32 s30, 147456
    s_mov_b32 s31, 0x20000
    s_mul_i32 s36, s14, 1179648
    s_lshl_b32 s37, s15, 8
    s_add_u32 s36, s36, s37
    s_add_u32 s32, s12, s36
    s_addc_u32 s33, s13, 0
    s_and_b32 s33, s33, 0xffff
    s_sub_u32 s34, 1179648, s37
    s_mov_b32 s35, 0x20000
    s_lshl_b32 s36, s3, 10
    s_sub_u32 s37, 2, s3
    s_lshl_b32 s37, s37, 10
    s_and_b32 s40, s3, 1
    s_lshl_b32 s40, s40, 3
    v_lshlrev_b32 v9, 1, v3
    v_xor_b32 v9, v9, v2
    v_xor_b32 v14, s40, v9
    v_xor_b32 v15, 8, v14
    v_lshlrev_b32 v9, 8, v3
    v_lshl_add_u32 v4, v14, 4, v9
    v_lshl_add_u32 v16, v15, 4, v9
    v_lshlrev_b32 v9, 13, v3
    v_lshl_add_u32 v5, v14, 4, v9
    v_lshl_add_u32 v17, v15, 4, v9
    v_mov_b32 v14, v16
    v_mov_b32 v15, v17
    v_and_b32 v9, 7, v2
    v_lshlrev_b32 v9, 1, v9
    v_xor_b32 v9, v9, v3
    v_lshlrev_b32 v6, 8, v2
    v_lshl_add_u32 v6, v9, 4, v6
    v_lshrrev_b32 v9, 2, v2
    v_lshl_add_u32 v9, v3, 3, v9
    v_lshlrev_b32 v7, 8, v9
    v_and_b32 v9, 7, v9
    v_lshlrev_b32 v9, 1, v9
    v_bfe_u32 v10, v2, 1, 1
    v_xor_b32 v9, v9, v10
    v_lshl_add_u32 v7, v9, 4, v7
    v_and_b32 v9, 1, v2
    v_lshl_add_u32 v7, v9, 3, v7
    v_lshrrev_b32 v9, 2, v2
    v_lshl_add_u32 v9, v3, 2, v9
    v_lshlrev_b32 v8, 8, v9
    v_and_b32 v9, 7, v9
    v_lshlrev_b32 v9, 1, v9
    v_bfe_u32 v10, v2, 1, 1
    v_xor_b32 v9, v9, v10
    v_lshl_add_u32 v8, v9, 4, v8
    v_and_b32 v9, 1, v2
    v_lshl_add_u32 v8, v9, 3, v8
    v_add_u32 v8, 0x4000, v8
    s_mul_i32 s38, s3, 48
    v_add_u32 v10, s38, v2
    v_lshlrev_b32 v10, 10, v10
    v_lshl_add_u32 v10, v3, 4, v10
    v_add_u32 v11, s38, v2
    v_lshlrev_b32 v11, 13, v11
    v_lshl_add_u32 v11, v3, 3, v11
    s_lshl_b32 s39, s3, 12
    s_add_u32 s39, s39, 0x10000
    v_lshlrev_b32 v12, 8, v2
    v_lshl_add_u32 v12, v3, 3, v12
    v_add_u32 v12, s39, v12
    v_lshlrev_b32 v13, 8, v2
    v_lshl_add_u32 v13, v3, 4, v13
    v_add_u32 v13, s39, v13
    v_mov_b32 v64, 0
    v_mov_b32 v65, 0
    v_mov_b32 v66, 0
    v_mov_b32 v67, 0
    v_mov_b32 v68, 0
    v_mov_b32 v69, 0
    v_mov_b32 v70, 0
    v_mov_b32 v71, 0
    v_mov_b32 v72, 0
    v_mov_b32 v73, 0
    v_mov_b32 v74, 0
    v_mov_b32 v75, 0
    v_mov_b32 v76, 0
    v_mov_b32 v77, 0
    v_mov_b32 v78, 0
    v_mov_b32 v79, 0
    v_mov_b32 v80, 0
    v_mov_b32 v81, 0
    v_mov_b32 v82, 0
    v_mov_b32 v83, 0
    v_mov_b32 v84, 0
    v_mov_b32 v85, 0
    v_mov_b32 v86, 0
    v_mov_b32 v87, 0
    v_mov_b32 v88, 0
    v_mov_b32 v89, 0
    v_mov_b32 v90, 0
    v_mov_b32 v91, 0
    v_mov_b32 v92, 0
    v_mov_b32 v93, 0
    v_mov_b32 v94, 0
    v_mov_b32 v95, 0
    v_mov_b32 v96, 0
    v_mov_b32 v97, 0
    v_mov_b32 v98, 0
    v_mov_b32 v99, 0
    v_mov_b32 v100, 0
    v_mov_b32 v101, 0
    v_mov_b32 v102, 0
    v_mov_b32 v103, 0
    v_mov_b32 v104, 0
    v_mov_b32 v105, 0
    v_mov_b32 v106, 0
    v_mov_b32 v107, 0
    v_mov_b32 v108, 0
    v_mov_b32 v109, 0
    v_mov_b32 v110, 0
    v_mov_b32 v111, 0
    v_mov_b32 v112, 0
    v_mov_b32 v113, 0
    v_mov_b32 v114, 0
    v_mov_b32 v115, 0
    v_mov_b32 v116, 0
    v_mov_b32 v117, 0
    v_mov_b32 v118, 0
    v_mov_b32 v119, 0
    v_mov_b32 v120, 0
    v_mov_b32 v121, 0
    v_mov_b32 v122, 0
    v_mov_b32 v123, 0
    v_mov_b32 v124, 0
    v_mov_b32 v125, 0
    v_mov_b32 v126, 0
    v_mov_b32 v127, 0
    v_mov_b32 v128, 0
    v_mov_b32 v129, 0
    v_mov_b32 v130, 0
    v_mov_b32 v131, 0
    v_mov_b32 v132, 0
    v_mov_b32 v133, 0
    v_mov_b32 v134, 0
    v_mov_b32 v135, 0
    v_mov_b32 v136, 0
    v_mov_b32 v137, 0
    v_mov_b32 v138, 0
    v_mov_b32 v139, 0
    v_mov_b32 v140, 0
    v_mov_b32 v141, 0
    v_mov_b32 v142, 0
    v_mov_b32 v143, 0
    v_mov_b32 v144, 0
    v_mov_b32 v145, 0
    v_mov_b32 v146, 0
    v_mov_b32 v147, 0
    v_mov_b32 v148, 0
    v_mov_b32 v149, 0
    v_mov_b32 v150, 0
    v_mov_b32 v151, 0
    v_mov_b32 v152, 0
    v_mov_b32 v153, 0
    v_mov_b32 v154, 0
    v_mov_b32 v155, 0
    v_mov_b32 v156, 0
    v_mov_b32 v157, 0
    v_mov_b32 v158, 0
    v_mov_b32 v159, 0
    s_add_u32 m0, s36, 0
    s_lshl_b32 s40, s3, 15
    s_add_u32 s40, s40, 0
    buffer_load_dwordx4 v5, s[24:27], s40 offen lds
    s_add_u32 m0, s36, 3072
    s_lshl_b32 s40, s3, 15
    s_add_u32 s40, s40, 98304
    buffer_load_dwordx4 v15, s[24:27], s40 offen lds
    s_add_u32 m0, s36, 6144
    s_lshl_b32 s40, s3, 15
    s_add_u32 s40, s40, 196608
    buffer_load_dwordx4 v5, s[24:27], s40 offen lds
    s_add_u32 m0, s36, 9216
    s_lshl_b32 s40, s3, 15
    s_add_u32 s40, s40, 294912
    buffer_load_dwordx4 v15, s[24:27], s40 offen lds
    s_add_u32 m0, s36, 12288
    s_lshl_b32 s40, s3, 15
    s_add_u32 s40, s40, 393216
    buffer_load_dwordx4 v5, s[24:27], s40 offen lds
    s_cmp_lg_u32 s3, 0
    s_cbranch_scc1 wq_skip_0
    s_add_u32 m0, s36, 15360
    s_lshl_b32 s40, s3, 15
    s_add_u32 s40, s40, 491520
    buffer_load_dwordx4 v15, s[24:27], s40 offen lds
wq_skip_0:
    s_mov_b32 s41, 0
    buffer_load_dwordx4 v[160:163], v10, s[28:31], s41 offen offset:0
    buffer_load_dwordx4 v[164:167], v10, s[28:31], s41 offen offset:64
    s_mov_b32 s41, 16384
    buffer_load_dwordx4 v[168:171], v10, s[28:31], s41 offen offset:0
    buffer_load_dwordx4 v[172:175], v10, s[28:31], s41 offen offset:64
    s_mov_b32 s41, 32768
    buffer_load_dwordx4 v[176:179], v10, s[28:31], s41 offen offset:0
    buffer_load_dwordx4 v[180:183], v10, s[28:31], s41 offen offset:64
    s_add_u32 m0, s36, 16384
    s_lshl_b32 s40, s3, 15
    s_add_u32 s40, s40, 524288
    buffer_load_dwordx4 v5, s[24:27], s40 offen lds
    s_add_u32 m0, s36, 19456
    s_lshl_b32 s40, s3, 15
    s_add_u32 s40, s40, 622592
    buffer_load_dwordx4 v15, s[24:27], s40 offen lds
    s_add_u32 m0, s36, 22528
    s_lshl_b32 s40, s3, 15
    s_add_u32 s40, s40, 720896
    buffer_load_dwordx4 v5, s[24:27], s40 offen lds
    s_add_u32 m0, s36, 25600
    s_lshl_b32 s40, s3, 15
    s_add_u32 s40, s40, 819200
    buffer_load_dwordx4 v15, s[24:27], s40 offen lds
    s_add_u32 m0, s36, 28672
    s_lshl_b32 s40, s3, 15
    s_add_u32 s40, s40, 917504
    buffer_load_dwordx4 v5, s[24:27], s40 offen lds
    s_cmp_lg_u32 s3, 0
    s_cbranch_scc1 wq_skip_1
    s_add_u32 m0, s36, 31744
    s_lshl_b32 s40, s3, 15
    s_add_u32 s40, s40, 1015808
    buffer_load_dwordx4 v15, s[24:27], s40 offen lds
wq_skip_1:
    s_mov_b32 s41, 0
    buffer_load_dwordx4 v[184:187], v10, s[28:31], s41 offen offset:128
    buffer_load_dwordx4 v[188:191], v10, s[28:31], s41 offen offset:192
    s_mov_b32 s41, 16384
    buffer_load_dwordx4 v[192:195], v10, s[28:31], s41 offen offset:128
    buffer_load_dwordx4 v[196:199], v10, s[28:31], s41 offen offset:192
    s_mov_b32 s41, 32768
    buffer_load_dwordx4 v[200:203], v10, s[28:31], s41 offen offset:128
    buffer_load_dwordx4 v[204:207], v10, s[28:31], s41 offen offset:192
    s_add_u32 m0, s36, 32768
    s_lshl_b32 s40, s3, 15
    s_add_u32 s40, s40, 1048576
    buffer_load_dwordx4 v5, s[24:27], s40 offen lds
    s_add_u32 m0, s36, 35840
    s_lshl_b32 s40, s3, 15
    s_add_u32 s40, s40, 1146880
    buffer_load_dwordx4 v15, s[24:27], s40 offen lds
    s_add_u32 m0, s36, 38912
    s_lshl_b32 s40, s3, 15
    s_add_u32 s40, s40, 1245184
    buffer_load_dwordx4 v5, s[24:27], s40 offen lds
    s_add_u32 m0, s36, 41984
    s_lshl_b32 s40, s3, 15
    s_add_u32 s40, s40, 1343488
    buffer_load_dwordx4 v15, s[24:27], s40 offen lds
    s_add_u32 m0, s36, 45056
    s_lshl_b32 s40, s3, 15
    s_add_u32 s40, s40, 1441792
    buffer_load_dwordx4 v5, s[24:27], s40 offen lds
    s_cmp_lg_u32 s3, 0
    s_cbranch_scc1 wq_skip_2
    s_add_u32 m0, s36, 48128
    s_lshl_b32 s40, s3, 15
    s_add_u32 s40, s40, 1540096
    buffer_load_dwordx4 v15, s[24:27], s40 offen lds
wq_skip_2:
    s_mov_b32 s41, 0
    buffer_load_dwordx4 v[16:19], v10, s[28:31], s41 offen offset:256
    buffer_load_dwordx4 v[20:23], v10, s[28:31], s41 offen offset:320
    s_mov_b32 s41, 16384
    buffer_load_dwordx4 v[24:27], v10, s[28:31], s41 offen offset:256
    buffer_load_dwordx4 v[28:31], v10, s[28:31], s41 offen offset:320
    s_mov_b32 s41, 32768
    buffer_load_dwordx4 v[32:35], v10, s[28:31], s41 offen offset:256
    buffer_load_dwordx4 v[36:39], v10, s[28:31], s41 offen offset:320
    s_cmp_lg_u32 s3, 0
    s_cbranch_scc1 qw_0
    s_waitcnt vmcnt(24)
qw_0:
    s_cmp_eq_u32 s3, 0
    s_cbranch_scc1 qx_0
    s_waitcnt vmcnt(22)
qx_0:
    s_barrier
    s_add_u32 m0, s36, 49152
    s_lshl_b32 s40, s3, 15
    s_add_u32 s40, s40, 1572864
    buffer_load_dwordx4 v5, s[24:27], s40 offen lds
    s_add_u32 m0, s36, 52224
    s_lshl_b32 s40, s3, 15
    s_add_u32 s40, s40, 1671168
    buffer_load_dwordx4 v15, s[24:27], s40 offen lds
    s_add_u32 m0, s36, 55296
    s_lshl_b32 s40, s3, 15
    s_add_u32 s40, s40, 1769472
    buffer_load_dwordx4 v5, s[24:27], s40 offen lds
    s_add_u32 m0, s36, 58368
    s_lshl_b32 s40, s3, 15
    s_add_u32 s40, s40, 1867776
    buffer_load_dwordx4 v15, s[24:27], s40 offen lds
    s_add_u32 m0, s36, 61440
    s_lshl_b32 s40, s3, 15
    s_add_u32 s40, s40, 1966080
    buffer_load_dwordx4 v5, s[24:27], s40 offen lds
    s_cmp_lg_u32 s3, 0
    s_cbranch_scc1 wq_skip_3
    s_add_u32 m0, s36, 64512
    s_lshl_b32 s40, s3, 15
    s_add_u32 s40, s40, 2064384
    buffer_load_dwordx4 v15, s[24:27], s40 offen lds
wq_skip_3:
    s_mov_b32 s41, 0
    buffer_load_dwordx4 v[40:43], v10, s[28:31], s41 offen offset:384
    buffer_load_dwordx4 v[44:47], v10, s[28:31], s41 offen offset:448
    s_mov_b32 s41, 16384
    buffer_load_dwordx4 v[48:51], v10, s[28:31], s41 offen offset:384
    buffer_load_dwordx4 v[52:55], v10, s[28:31], s41 offen offset:448
    s_mov_b32 s41, 32768
    buffer_load_dwordx4 v[56:59], v10, s[28:31], s41 offen offset:384
    buffer_load_dwordx4 v[60:63], v10, s[28:31], s41 offen offset:448
    v_xor_b32 v254, 0, v7
    v_xor_b32 v255, 128, v7
    ds_read_b64_tr_b16 v[208:209], v254 offset:0
    ds_read_b64_tr_b16 v[210:211], v255 offset:1024
    v_xor_b32 v254, 32, v7
    v_xor_b32 v255, 160, v7
    ds_read_b64_tr_b16 v[212:213], v254 offset:0
    ds_read_b64_tr_b16 v[214:215], v255 offset:1024
    v_xor_b32 v254, 64, v7
    v_xor_b32 v255, 192, v7
    ds_read_b64_tr_b16 v[216:217], v254 offset:0
    ds_read_b64_tr_b16 v[218:219], v255 offset:1024
    v_xor_b32 v254, 96, v7
    v_xor_b32 v255, 224, v7
    ds_read_b64_tr_b16 v[220:221], v254 offset:0
    ds_read_b64_tr_b16 v[222:223], v255 offset:1024
    v_xor_b32 v254, 128, v7
    v_xor_b32 v255, 0, v7
    ds_read_b64_tr_b16 v[224:225], v254 offset:0
    ds_read_b64_tr_b16 v[226:227], v255 offset:1024
    v_xor_b32 v254, 160, v7
    v_xor_b32 v255, 32, v7
    ds_read_b64_tr_b16 v[228:229], v254 offset:0
    ds_read_b64_tr_b16 v[230:231], v255 offset:1024
    s_waitcnt lgkmcnt(10)
    v_mfma_f32_16x16x32_bf16 v[64:67], v[208:211], v[160:163], v[64:67]
    v_mfma_f32_16x16x32_bf16 v[68:71], v[208:211], v[168:171], v[68:71]
    v_mfma_f32_16x16x32_bf16 v[72:75], v[208:211], v[176:179], v[72:75]
    v_xor_b32 v254, 192, v7
    v_xor_b32 v255, 64, v7
    ds_read_b64_tr_b16 v[232:233], v254 offset:0
    ds_read_b64_tr_b16 v[234:235], v255 offset:1024
    s_waitcnt lgkmcnt(10)
    v_mfma_f32_16x16x32_bf16 v[76:79], v[212:215], v[160:163], v[76:79]
    v_mfma_f32_16x16x32_bf16 v[80:83], v[212:215], v[168:171], v[80:83]
    v_mfma_f32_16x16x32_bf16 v[84:87], v[212:215], v[176:179], v[84:87]
    v_xor_b32 v254, 224, v7
    v_xor_b32 v255, 96, v7
    ds_read_b64_tr_b16 v[236:237], v254 offset:0
    ds_read_b64_tr_b16 v[238:239], v255 offset:1024
    s_waitcnt lgkmcnt(10)
    v_mfma_f32_16x16x32_bf16 v[88:91], v[216:219], v[160:163], v[88:91]
    v_mfma_f32_16x16x32_bf16 v[92:95], v[216:219], v[168:171], v[92:95]
    v_mfma_f32_16x16x32_bf16 v[96:99], v[216:219], v[176:179], v[96:99]
    v_xor_b32 v254, 0, v7
    v_xor_b32 v255, 128, v7
    ds_read_b64_tr_b16 v[240:241], v254 offset:8192
    ds_read_b64_tr_b16 v[242:243], v255 offset:9216
    s_waitcnt lgkmcnt(10)
    v_mfma_f32_16x16x32_bf16 v[100:103], v[220:223], v[160:163], v[100:103]
    v_mfma_f32_16x16x32_bf16 v[104:107], v[220:223], v[168:171], v[104:107]
    v_mfma_f32_16x16x32_bf16 v[108:111], v[220:223], v[176:179], v[108:111]
    v_xor_b32 v254, 32, v7
    v_xor_b32 v255, 160, v7
    ds_read_b64_tr_b16 v[244:245], v254 offset:8192
    ds_read_b64_tr_b16 v[246:247], v255 offset:9216
    s_waitcnt lgkmcnt(10)
    v_mfma_f32_16x16x32_bf16 v[112:115], v[224:227], v[160:163], v[112:115]
    v_mfma_f32_16x16x32_bf16 v[116:119], v[224:227], v[168:171], v[116:119]
    v_mfma_f32_16x16x32_bf16 v[120:123], v[224:227], v[176:179], v[120:123]
    v_xor_b32 v254, 64, v7
    v_xor_b32 v255, 192, v7
    ds_read_b64_tr_b16 v[208:209], v254 offset:8192
    ds_read_b64_tr_b16 v[210:211], v255 offset:9216
    s_waitcnt lgkmcnt(10)
    v_mfma_f32_16x16x32_bf16 v[124:127], v[228:231], v[160:163], v[124:127]
    v_mfma_f32_16x16x32_bf16 v[128:131], v[228:231], v[168:171], v[128:131]
    v_mfma_f32_16x16x32_bf16 v[132:135], v[228:231], v[176:179], v[132:135]
    v_xor_b32 v254, 96, v7
    v_xor_b32 v255, 224, v7
    ds_read_b64_tr_b16 v[212:213], v254 offset:8192
    ds_read_b64_tr_b16 v[214:215], v255 offset:9216
    s_waitcnt lgkmcnt(10)
    v_mfma_f32_16x16x32_bf16 v[136:139], v[232:235], v[160:163], v[136:139]
    v_mfma_f32_16x16x32_bf16 v[140:143], v[232:235], v[168:171], v[140:143]
    v_mfma_f32_16x16x32_bf16 v[144:147], v[232:235], v[176:179], v[144:147]
    v_xor_b32 v254, 128, v7
    v_xor_b32 v255, 0, v7
    ds_read_b64_tr_b16 v[216:217], v254 offset:8192
    ds_read_b64_tr_b16 v[218:219], v255 offset:9216
    s_waitcnt lgkmcnt(10)
    v_mfma_f32_16x16x32_bf16 v[148:151], v[236:239], v[160:163], v[148:151]
    v_mfma_f32_16x16x32_bf16 v[152:155], v[236:239], v[168:171], v[152:155]
    v_mfma_f32_16x16x32_bf16 v[156:159], v[236:239], v[176:179], v[156:159]
    v_xor_b32 v254, 160, v7
    v_xor_b32 v255, 32, v7
    ds_read_b64_tr_b16 v[220:221], v254 offset:8192
    ds_read_b64_tr_b16 v[222:223], v255 offset:9216
    s_waitcnt lgkmcnt(10)
    v_mfma_f32_16x16x32_bf16 v[64:67], v[240:243], v[164:167], v[64:67]
    v_mfma_f32_16x16x32_bf16 v[68:71], v[240:243], v[172:175], v[68:71]
    v_mfma_f32_16x16x32_bf16 v[72:75], v[240:243], v[180:183], v[72:75]
    v_xor_b32 v254, 192, v7
    v_xor_b32 v255, 64, v7
    ds_read_b64_tr_b16 v[224:225], v254 offset:8192
    ds_read_b64_tr_b16 v[226:227], v255 offset:9216
    s_waitcnt lgkmcnt(10)
    v_mfma_f32_16x16x32_bf16 v[76:79], v[244:247], v[164:167], v[76:79]
    v_mfma_f32_16x16x32_bf16 v[80:83], v[244:247], v[172:175], v[80:83]
    v_mfma_f32_16x16x32_bf16 v[84:87], v[244:247], v[180:183], v[84:87]
    v_xor_b32 v254, 224, v7
    v_xor_b32 v255, 96, v7
    ds_read_b64_tr_b16 v[228:229], v254 offset:8192
    ds_read_b64_tr_b16 v[230:231], v255 offset:9216
    s_waitcnt lgkmcnt(10)
    v_mfma_f32_16x16x32_bf16 v[88:91], v[208:211], v[164:167], v[88:91]
    v_mfma_f32_16x16x32_bf16 v[92:95], v[208:211], v[172:175], v[92:95]
    v_mfma_f32_16x16x32_bf16 v[96:99], v[208:211], v[180:183], v[96:99]
    s_waitcnt lgkmcnt(8)
    v_mfma_f32_16x16x32_bf16 v[100:103], v[212:215], v[164:167], v[100:103]
    v_mfma_f32_16x16x32_bf16 v[104:107], v[212:215], v[172:175], v[104:107]
    v_mfma_f32_16x16x32_bf16 v[108:111], v[212:215], v[180:183], v[108:111]
    s_waitcnt lgkmcnt(6)
    v_mfma_f32_16x16x32_bf16 v[112:115], v[216:219], v[164:167], v[112:115]
    v_mfma_f32_16x16x32_bf16 v[116:119], v[216:219], v[172:175], v[116:119]
    v_mfma_f32_16x16x32_bf16 v[120:123], v[216:219], v[180:183], v[120:123]
    s_waitcnt lgkmcnt(4)
    v_mfma_f32_16x16x32_bf16 v[124:127], v[220:223], v[164:167], v[124:127]
    v_mfma_f32_16x16x32_bf16 v[128:131], v[220:223], v[172:175], v[128:131]
    v_mfma_f32_16x16x32_bf16 v[132:135], v[220:223], v[180:183], v[132:135]
    s_waitcnt lgkmcnt(2)
    v_mfma_f32_16x16x32_bf16 v[136:139], v[224:227], v[164:167], v[136:139]
    v_mfma_f32_16x16x32_bf16 v[140:143], v[224:227], v[172:175], v[140:143]
    v_mfma_f32_16x16x32_bf16 v[144:147], v[224:227], v[180:183], v[144:147]
    s_waitcnt lgkmcnt(0)
    v_mfma_f32_16x16x32_bf16 v[148:151], v[228:231], v[164:167], v[148:151]
    v_mfma_f32_16x16x32_bf16 v[152:155], v[228:231], v[172:175], v[152:155]
    v_mfma_f32_16x16x32_bf16 v[156:159], v[228:231], v[180:183], v[156:159]
    s_cmp_lg_u32 s3, 0
    s_cbranch_scc1 qw_1
    s_waitcnt vmcnt(24)
qw_1:
    s_cmp_eq_u32 s3, 0
    s_cbranch_scc1 qx_1
    s_waitcnt vmcnt(22)
qx_1:
    s_barrier
    s_add_u32 m0, s36, 0
    s_lshl_b32 s40, s3, 15
    s_add_u32 s40, s40, 2097152
    buffer_load_dwordx4 v5, s[24:27], s40 offen lds
    s_add_u32 m0, s36, 3072
    s_lshl_b32 s40, s3, 15
    s_add_u32 s40, s40, 2195456
    buffer_load_dwordx4 v15, s[24:27], s40 offen lds
    s_add_u32 m0, s36, 6144
    s_lshl_b32 s40, s3, 15
    s_add_u32 s40, s40, 2293760
    buffer_load_dwordx4 v5, s[24:27], s40 offen lds
    s_add_u32 m0, s36, 9216
    s_lshl_b32 s40, s3, 15
    s_add_u32 s40, s40, 2392064
    buffer_load_dwordx4 v15, s[24:27], s40 offen lds
    s_add_u32 m0, s36, 12288
    s_lshl_b32 s40, s3, 15
    s_add_u32 s40, s40, 2490368
    buffer_load_dwordx4 v5, s[24:27], s40 offen lds
    s_cmp_lg_u32 s3, 0
    s_cbranch_scc1 wq_skip_4
    s_add_u32 m0, s36, 15360
    s_lshl_b32 s40, s3, 15
    s_add_u32 s40, s40, 2588672
    buffer_load_dwordx4 v15, s[24:27], s40 offen lds
wq_skip_4:
    s_mov_b32 s41, 0
    buffer_load_dwordx4 v[160:163], v10, s[28:31], s41 offen offset:512
    buffer_load_dwordx4 v[164:167], v10, s[28:31], s41 offen offset:576
    s_mov_b32 s41, 16384
    buffer_load_dwordx4 v[168:171], v10, s[28:31], s41 offen offset:512
    buffer_load_dwordx4 v[172:175], v10, s[28:31], s41 offen offset:576
    s_mov_b32 s41, 32768
    buffer_load_dwordx4 v[176:179], v10, s[28:31], s41 offen offset:512
    buffer_load_dwordx4 v[180:183], v10, s[28:31], s41 offen offset:576
    v_xor_b32 v254, 0, v7
    v_xor_b32 v255, 128, v7
    ds_read_b64_tr_b16 v[208:209], v254 offset:16384
    ds_read_b64_tr_b16 v[210:211], v255 offset:17408
    v_xor_b32 v254, 32, v7
    v_xor_b32 v255, 160, v7
    ds_read_b64_tr_b16 v[212:213], v254 offset:16384
    ds_read_b64_tr_b16 v[214:215], v255 offset:17408
    v_xor_b32 v254, 64, v7
    v_xor_b32 v255, 192, v7
    ds_read_b64_tr_b16 v[216:217], v254 offset:16384
    ds_read_b64_tr_b16 v[218:219], v255 offset:17408
    v_xor_b32 v254, 96, v7
    v_xor_b32 v255, 224, v7
    ds_read_b64_tr_b16 v[220:221], v254 offset:16384
    ds_read_b64_tr_b16 v[222:223], v255 offset:17408
    v_xor_b32 v254, 128, v7
    v_xor_b32 v255, 0, v7
    ds_read_b64_tr_b16 v[224:225], v254 offset:16384
    ds_read_b64_tr_b16 v[226:227], v255 offset:17408
    v_xor_b32 v254, 160, v7
    v_xor_b32 v255, 32, v7
    ds_read_b64_tr_b16 v[228:229], v254 offset:16384
    ds_read_b64_tr_b16 v[230:231], v255 offset:17408
    s_waitcnt lgkmcnt(10)
    v_mfma_f32_16x16x32_bf16 v[64:67], v[208:211], v[184:187], v[64:67]
    v_mfma_f32_16x16x32_bf16 v[68:71], v[208:211], v[192:195], v[68:71]
    v_mfma_f32_16x16x32_bf16 v[72:75], v[208:211], v[200:203], v[72:75]
    v_xor_b32 v254, 192, v7
    v_xor_b32 v255, 64, v7
    ds_read_b64_tr_b16 v[232:233], v254 offset:16384
    ds_read_b64_tr_b16 v[234:235], v255 offset:17408
    s_waitcnt lgkmcnt(10)
    v_mfma_f32_16x16x32_bf16 v[76:79], v[212:215], v[184:187], v[76:79]
    v_mfma_f32_16x16x32_bf16 v[80:83], v[212:215], v[192:195], v[80:83]
    v_mfma_f32_16x16x32_bf16 v[84:87], v[212:215], v[200:203], v[84:87]
    v_xor_b32 v254, 224, v7
    v_xor_b32 v255, 96, v7
    ds_read_b64_tr_b16 v[236:237], v254 offset:16384
    ds_read_b64_tr_b16 v[238:239], v255 offset:17408
    s_waitcnt lgkmcnt(10)
    v_mfma_f32_16x16x32_bf16 v[88:91], v[216:219], v[184:187], v[88:91]
    v_mfma_f32_16x16x32_bf16 v[92:95], v[216:219], v[192:195], v[92:95]
    v_mfma_f32_16x16x32_bf16 v[96:99], v[216:219], v[200:203], v[96:99]
    v_xor_b32 v254, 0, v7
    v_xor_b32 v255, 128, v7
    ds_read_b64_tr_b16 v[240:241], v254 offset:24576
    ds_read_b64_tr_b16 v[242:243], v255 offset:25600
    s_waitcnt lgkmcnt(10)
    v_mfma_f32_16x16x32_bf16 v[100:103], v[220:223], v[184:187], v[100:103]
    v_mfma_f32_16x16x32_bf16 v[104:107], v[220:223], v[192:195], v[104:107]
    v_mfma_f32_16x16x32_bf16 v[108:111], v[220:223], v[200:203], v[108:111]
    v_xor_b32 v254, 32, v7
    v_xor_b32 v255, 160, v7
    ds_read_b64_tr_b16 v[244:245], v254 offset:24576
    ds_read_b64_tr_b16 v[246:247], v255 offset:25600
    s_waitcnt lgkmcnt(10)
    v_mfma_f32_16x16x32_bf16 v[112:115], v[224:227], v[184:187], v[112:115]
    v_mfma_f32_16x16x32_bf16 v[116:119], v[224:227], v[192:195], v[116:119]
    v_mfma_f32_16x16x32_bf16 v[120:123], v[224:227], v[200:203], v[120:123]
    v_xor_b32 v254, 64, v7
    v_xor_b32 v255, 192, v7
    ds_read_b64_tr_b16 v[208:209], v254 offset:24576
    ds_read_b64_tr_b16 v[210:211], v255 offset:25600
    s_waitcnt lgkmcnt(10)
    v_mfma_f32_16x16x32_bf16 v[124:127], v[228:231], v[184:187], v[124:127]
    v_mfma_f32_16x16x32_bf16 v[128:131], v[228:231], v[192:195], v[128:131]
    v_mfma_f32_16x16x32_bf16 v[132:135], v[228:231], v[200:203], v[132:135]
    v_xor_b32 v254, 96, v7
    v_xor_b32 v255, 224, v7
    ds_read_b64_tr_b16 v[212:213], v254 offset:24576
    ds_read_b64_tr_b16 v[214:215], v255 offset:25600
    s_waitcnt lgkmcnt(10)
    v_mfma_f32_16x16x32_bf16 v[136:139], v[232:235], v[184:187], v[136:139]
    v_mfma_f32_16x16x32_bf16 v[140:143], v[232:235], v[192:195], v[140:143]
    v_mfma_f32_16x16x32_bf16 v[144:147], v[232:235], v[200:203], v[144:147]
    v_xor_b32 v254, 128, v7
    v_xor_b32 v255, 0, v7
    ds_read_b64_tr_b16 v[216:217], v254 offset:24576
    ds_read_b64_tr_b16 v[218:219], v255 offset:25600
    s_waitcnt lgkmcnt(10)
    v_mfma_f32_16x16x32_bf16 v[148:151], v[236:239], v[184:187], v[148:151]
    v_mfma_f32_16x16x32_bf16 v[152:155], v[236:239], v[192:195], v[152:155]
    v_mfma_f32_16x16x32_bf16 v[156:159], v[236:239], v[200:203], v[156:159]
    v_xor_b32 v254, 160, v7
    v_xor_b32 v255, 32, v7
    ds_read_b64_tr_b16 v[220:221], v254 offset:24576
    ds_read_b64_tr_b16 v[222:223], v255 offset:25600
    s_waitcnt lgkmcnt(10)
    v_mfma_f32_16x16x32_bf16 v[64:67], v[240:243], v[188:191], v[64:67]
    v_mfma_f32_16x16x32_bf16 v[68:71], v[240:243], v[196:199], v[68:71]
    v_mfma_f32_16x16x32_bf16 v[72:75], v[240:243], v[204:207], v[72:75]
    v_xor_b32 v254, 192, v7
    v_xor_b32 v255, 64, v7
    ds_read_b64_tr_b16 v[224:225], v254 offset:24576
    ds_read_b64_tr_b16 v[226:227], v255 offset:25600
    s_waitcnt lgkmcnt(10)
    v_mfma_f32_16x16x32_bf16 v[76:79], v[244:247], v[188:191], v[76:79]
    v_mfma_f32_16x16x32_bf16 v[80:83], v[244:247], v[196:199], v[80:83]
    v_mfma_f32_16x16x32_bf16 v[84:87], v[244:247], v[204:207], v[84:87]
    v_xor_b32 v254, 224, v7
    v_xor_b32 v255, 96, v7
    ds_read_b64_tr_b16 v[228:229], v254 offset:24576
    ds_read_b64_tr_b16 v[230:231], v255 offset:25600
    s_waitcnt lgkmcnt(10)
    v_mfma_f32_16x16x32_bf16 v[88:91], v[208:211], v[188:191], v[88:91]
    v_mfma_f32_16x16x32_bf16 v[92:95], v[208:211], v[196:199], v[92:95]
    v_mfma_f32_16x16x32_bf16 v[96:99], v[208:211], v[204:207], v[96:99]
    s_waitcnt lgkmcnt(8)
    v_mfma_f32_16x16x32_bf16 v[100:103], v[212:215], v[188:191], v[100:103]
    v_mfma_f32_16x16x32_bf16 v[104:107], v[212:215], v[196:199], v[104:107]
    v_mfma_f32_16x16x32_bf16 v[108:111], v[212:215], v[204:207], v[108:111]
    s_waitcnt lgkmcnt(6)
    v_mfma_f32_16x16x32_bf16 v[112:115], v[216:219], v[188:191], v[112:115]
    v_mfma_f32_16x16x32_bf16 v[116:119], v[216:219], v[196:199], v[116:119]
    v_mfma_f32_16x16x32_bf16 v[120:123], v[216:219], v[204:207], v[120:123]
    s_waitcnt lgkmcnt(4)
    v_mfma_f32_16x16x32_bf16 v[124:127], v[220:223], v[188:191], v[124:127]
    v_mfma_f32_16x16x32_bf16 v[128:131], v[220:223], v[196:199], v[128:131]
    v_mfma_f32_16x16x32_bf16 v[132:135], v[220:223], v[204:207], v[132:135]
    s_waitcnt lgkmcnt(2)
    v_mfma_f32_16x16x32_bf16 v[136:139], v[224:227], v[188:191], v[136:139]
    v_mfma_f32_16x16x32_bf16 v[140:143], v[224:227], v[196:199], v[140:143]
    v_mfma_f32_16x16x32_bf16 v[144:147], v[224:227], v[204:207], v[144:147]
    s_waitcnt lgkmcnt(0)
    v_mfma_f32_16x16x32_bf16 v[148:151], v[228:231], v[188:191], v[148:151]
    v_mfma_f32_16x16x32_bf16 v[152:155], v[228:231], v[196:199], v[152:155]
    v_mfma_f32_16x16x32_bf16 v[156:159], v[228:231], v[204:207], v[156:159]
    s_cmp_lg_u32 s3, 0
    s_cbranch_scc1 qw_2
    s_waitcnt vmcnt(24)
qw_2:
    s_cmp_eq_u32 s3, 0
    s_cbranch_scc1 qx_2
    s_waitcnt vmcnt(22)
qx_2:
    s_barrier
    s_add_u32 m0, s36, 16384
    s_lshl_b32 s40, s3, 15
    s_add_u32 s40, s40, 2621440
    buffer_load_dwordx4 v5, s[24:27], s40 offen lds
    s_add_u32 m0, s36, 19456
    s_lshl_b32 s40, s3, 15
    s_add_u32 s40, s40, 2719744
    buffer_load_dwordx4 v15, s[24:27], s40 offen lds
    s_add_u32 m0, s36, 22528
    s_lshl_b32 s40, s3, 15
    s_add_u32 s40, s40, 2818048
    buffer_load_dwordx4 v5, s[24:27], s40 offen lds
    s_add_u32 m0, s36, 25600
    s_lshl_b32 s40, s3, 15
    s_add_u32 s40, s40, 2916352
    buffer_load_dwordx4 v15, s[24:27], s40 offen lds
    s_add_u32 m0, s36, 28672
    s_lshl_b32 s40, s3, 15
    s_add_u32 s40, s40, 3014656
    buffer_load_dwordx4 v5, s[24:27], s40 offen lds
    s_cmp_lg_u32 s3, 0
    s_cbranch_scc1 wq_skip_5
    s_add_u32 m0, s36, 31744
    s_lshl_b32 s40, s3, 15
    s_add_u32 s40, s40, 3112960
    buffer_load_dwordx4 v15, s[24:27], s40 offen lds
wq_skip_5:
    s_mov_b32 s41, 0
    buffer_load_dwordx4 v[184:187], v10, s[28:31], s41 offen offset:640
    buffer_load_dwordx4 v[188:191], v10, s[28:31], s41 offen offset:704
    s_mov_b32 s41, 16384
    buffer_load_dwordx4 v[192:195], v10, s[28:31], s41 offen offset:640
    buffer_load_dwordx4 v[196:199], v10, s[28:31], s41 offen offset:704
    s_mov_b32 s41, 32768
    buffer_load_dwordx4 v[200:203], v10, s[28:31], s41 offen offset:640
    buffer_load_dwordx4 v[204:207], v10, s[28:31], s41 offen offset:704
    v_xor_b32 v254, 0, v7
    v_xor_b32 v255, 128, v7
    ds_read_b64_tr_b16 v[208:209], v254 offset:32768
    ds_read_b64_tr_b16 v[210:211], v255 offset:33792
    v_xor_b32 v254, 32, v7
    v_xor_b32 v255, 160, v7
    ds_read_b64_tr_b16 v[212:213], v254 offset:32768
    ds_read_b64_tr_b16 v[214:215], v255 offset:33792
    v_xor_b32 v254, 64, v7
    v_xor_b32 v255, 192, v7
    ds_read_b64_tr_b16 v[216:217], v254 offset:32768
    ds_read_b64_tr_b16 v[218:219], v255 offset:33792
    v_xor_b32 v254, 96, v7
    v_xor_b32 v255, 224, v7
    ds_read_b64_tr_b16 v[220:221], v254 offset:32768
    ds_read_b64_tr_b16 v[222:223], v255 offset:33792
    v_xor_b32 v254, 128, v7
    v_xor_b32 v255, 0, v7
    ds_read_b64_tr_b16 v[224:225], v254 offset:32768
    ds_read_b64_tr_b16 v[226:227], v255 offset:33792
    v_xor_b32 v254, 160, v7
    v_xor_b32 v255, 32, v7
    ds_read_b64_tr_b16 v[228:229], v254 offset:32768
    ds_read_b64_tr_b16 v[230:231], v255 offset:33792
    s_waitcnt lgkmcnt(10)
    v_mfma_f32_16x16x32_bf16 v[64:67], v[208:211], v[16:19], v[64:67]
    v_mfma_f32_16x16x32_bf16 v[68:71], v[208:211], v[24:27], v[68:71]
    v_mfma_f32_16x16x32_bf16 v[72:75], v[208:211], v[32:35], v[72:75]
    v_xor_b32 v254, 192, v7
    v_xor_b32 v255, 64, v7
    ds_read_b64_tr_b16 v[232:233], v254 offset:32768
    ds_read_b64_tr_b16 v[234:235], v255 offset:33792
    s_waitcnt lgkmcnt(10)
    v_mfma_f32_16x16x32_bf16 v[76:79], v[212:215], v[16:19], v[76:79]
    v_mfma_f32_16x16x32_bf16 v[80:83], v[212:215], v[24:27], v[80:83]
    v_mfma_f32_16x16x32_bf16 v[84:87], v[212:215], v[32:35], v[84:87]
    v_xor_b32 v254, 224, v7
    v_xor_b32 v255, 96, v7
    ds_read_b64_tr_b16 v[236:237], v254 offset:32768
    ds_read_b64_tr_b16 v[238:239], v255 offset:33792
    s_waitcnt lgkmcnt(10)
    v_mfma_f32_16x16x32_bf16 v[88:91], v[216:219], v[16:19], v[88:91]
    v_mfma_f32_16x16x32_bf16 v[92:95], v[216:219], v[24:27], v[92:95]
    v_mfma_f32_16x16x32_bf16 v[96:99], v[216:219], v[32:35], v[96:99]
    v_xor_b32 v254, 0, v7
    v_xor_b32 v255, 128, v7
    ds_read_b64_tr_b16 v[240:241], v254 offset:40960
    ds_read_b64_tr_b16 v[242:243], v255 offset:41984
    s_waitcnt lgkmcnt(10)
    v_mfma_f32_16x16x32_bf16 v[100:103], v[220:223], v[16:19], v[100:103]
    v_mfma_f32_16x16x32_bf16 v[104:107], v[220:223], v[24:27], v[104:107]
    v_mfma_f32_16x16x32_bf16 v[108:111], v[220:223], v[32:35], v[108:111]
    v_xor_b32 v254, 32, v7
    v_xor_b32 v255, 160, v7
    ds_read_b64_tr_b16 v[244:245], v254 offset:40960
    ds_read_b64_tr_b16 v[246:247], v255 offset:41984
    s_waitcnt lgkmcnt(10)
    v_mfma_f32_16x16x32_bf16 v[112:115], v[224:227], v[16:19], v[112:115]
    v_mfma_f32_16x16x32_bf16 v[116:119], v[224:227], v[24:27], v[116:119]
    v_mfma_f32_16x16x32_bf16 v[120:123], v[224:227], v[32:35], v[120:123]
    v_xor_b32 v254, 64, v7
    v_xor_b32 v255, 192, v7
    ds_read_b64_tr_b16 v[208:209], v254 offset:40960
    ds_read_b64_tr_b16 v[210:211], v255 offset:41984
    s_waitcnt lgkmcnt(10)
    v_mfma_f32_16x16x32_bf16 v[124:127], v[228:231], v[16:19], v[124:127]
    v_mfma_f32_16x16x32_bf16 v[128:131], v[228:231], v[24:27], v[128:131]
    v_mfma_f32_16x16x32_bf16 v[132:135], v[228:231], v[32:35], v[132:135]
    v_xor_b32 v254, 96, v7
    v_xor_b32 v255, 224, v7
    ds_read_b64_tr_b16 v[212:213], v254 offset:40960
    ds_read_b64_tr_b16 v[214:215], v255 offset:41984
    s_waitcnt lgkmcnt(10)
    v_mfma_f32_16x16x32_bf16 v[136:139], v[232:235], v[16:19], v[136:139]
    v_mfma_f32_16x16x32_bf16 v[140:143], v[232:235], v[24:27], v[140:143]
    v_mfma_f32_16x16x32_bf16 v[144:147], v[232:235], v[32:35], v[144:147]
    v_xor_b32 v254, 128, v7
    v_xor_b32 v255, 0, v7
    ds_read_b64_tr_b16 v[216:217], v254 offset:40960
    ds_read_b64_tr_b16 v[218:219], v255 offset:41984
    s_waitcnt lgkmcnt(10)
    v_mfma_f32_16x16x32_bf16 v[148:151], v[236:239], v[16:19], v[148:151]
    v_mfma_f32_16x16x32_bf16 v[152:155], v[236:239], v[24:27], v[152:155]
    v_mfma_f32_16x16x32_bf16 v[156:159], v[236:239], v[32:35], v[156:159]
    v_xor_b32 v254, 160, v7
    v_xor_b32 v255, 32, v7
    ds_read_b64_tr_b16 v[220:221], v254 offset:40960
    ds_read_b64_tr_b16 v[222:223], v255 offset:41984
    s_waitcnt lgkmcnt(10)
    v_mfma_f32_16x16x32_bf16 v[64:67], v[240:243], v[20:23], v[64:67]
    v_mfma_f32_16x16x32_bf16 v[68:71], v[240:243], v[28:31], v[68:71]
    v_mfma_f32_16x16x32_bf16 v[72:75], v[240:243], v[36:39], v[72:75]
    v_xor_b32 v254, 192, v7
    v_xor_b32 v255, 64, v7
    ds_read_b64_tr_b16 v[224:225], v254 offset:40960
    ds_read_b64_tr_b16 v[226:227], v255 offset:41984
    s_waitcnt lgkmcnt(10)
    v_mfma_f32_16x16x32_bf16 v[76:79], v[244:247], v[20:23], v[76:79]
    v_mfma_f32_16x16x32_bf16 v[80:83], v[244:247], v[28:31], v[80:83]
    v_mfma_f32_16x16x32_bf16 v[84:87], v[244:247], v[36:39], v[84:87]
    v_xor_b32 v254, 224, v7
    v_xor_b32 v255, 96, v7
    ds_read_b64_tr_b16 v[228:229], v254 offset:40960
    ds_read_b64_tr_b16 v[230:231], v255 offset:41984
    s_waitcnt lgkmcnt(10)
    v_mfma_f32_16x16x32_bf16 v[88:91], v[208:211], v[20:23], v[88:91]
    v_mfma_f32_16x16x32_bf16 v[92:95], v[208:211], v[28:31], v[92:95]
    v_mfma_f32_16x16x32_bf16 v[96:99], v[208:211], v[36:39], v[96:99]
    s_waitcnt lgkmcnt(8)
    v_mfma_f32_16x16x32_bf16 v[100:103], v[212:215], v[20:23], v[100:103]
    v_mfma_f32_16x16x32_bf16 v[104:107], v[212:215], v[28:31], v[104:107]
    v_mfma_f32_16x16x32_bf16 v[108:111], v[212:215], v[36:39], v[108:111]
    s_waitcnt lgkmcnt(6)
    v_mfma_f32_16x16x32_bf16 v[112:115], v[216:219], v[20:23], v[112:115]
    v_mfma_f32_16x16x32_bf16 v[116:119], v[216:219], v[28:31], v[116:119]
    v_mfma_f32_16x16x32_bf16 v[120:123], v[216:219], v[36:39], v[120:123]
    s_waitcnt lgkmcnt(4)
    v_mfma_f32_16x16x32_bf16 v[124:127], v[220:223], v[20:23], v[124:127]
    v_mfma_f32_16x16x32_bf16 v[128:131], v[220:223], v[28:31], v[128:131]
    v_mfma_f32_16x16x32_bf16 v[132:135], v[220:223], v[36:39], v[132:135]
    s_waitcnt lgkmcnt(2)
    v_mfma_f32_16x16x32_bf16 v[136:139], v[224:227], v[20:23], v[136:139]
    v_mfma_f32_16x16x32_bf16 v[140:143], v[224:227], v[28:31], v[140:143]
    v_mfma_f32_16x16x32_bf16 v[144:147], v[224:227], v[36:39], v[144:147]
    s_waitcnt lgkmcnt(0)
    v_mfma_f32_16x16x32_bf16 v[148:151], v[228:231], v[20:23], v[148:151]
    v_mfma_f32_16x16x32_bf16 v[152:155], v[228:231], v[28:31], v[152:155]
    v_mfma_f32_16x16x32_bf16 v[156:159], v[228:231], v[36:39], v[156:159]
    s_cmp_lg_u32 s3, 0
    s_cbranch_scc1 qw_3
    s_waitcnt vmcnt(24)
qw_3:
    s_cmp_eq_u32 s3, 0
    s_cbranch_scc1 qx_3
    s_waitcnt vmcnt(22)
qx_3:
    s_barrier
    s_add_u32 m0, s36, 32768
    s_lshl_b32 s40, s3, 15
    s_add_u32 s40, s40, 3145728
    buffer_load_dwordx4 v5, s[24:27], s40 offen lds
    s_add_u32 m0, s36, 35840
    s_lshl_b32 s40, s3, 15
    s_add_u32 s40, s40, 3244032
    buffer_load_dwordx4 v15, s[24:27], s40 offen lds
    s_add_u32 m0, s36, 38912
    s_lshl_b32 s40, s3, 15
    s_add_u32 s40, s40, 3342336
    buffer_load_dwordx4 v5, s[24:27], s40 offen lds
    s_add_u32 m0, s36, 41984
    s_lshl_b32 s40, s3, 15
    s_add_u32 s40, s40, 3440640
    buffer_load_dwordx4 v15, s[24:27], s40 offen lds
    s_add_u32 m0, s36, 45056
    s_lshl_b32 s40, s3, 15
    s_add_u32 s40, s40, 3538944
    buffer_load_dwordx4 v5, s[24:27], s40 offen lds
    s_cmp_lg_u32 s3, 0
    s_cbranch_scc1 wq_skip_6
    s_add_u32 m0, s36, 48128
    s_lshl_b32 s40, s3, 15
    s_add_u32 s40, s40, 3637248
    buffer_load_dwordx4 v15, s[24:27], s40 offen lds
wq_skip_6:
    s_mov_b32 s41, 0
    buffer_load_dwordx4 v[16:19], v10, s[28:31], s41 offen offset:768
    buffer_load_dwordx4 v[20:23], v10, s[28:31], s41 offen offset:832
    s_mov_b32 s41, 16384
    buffer_load_dwordx4 v[24:27], v10, s[28:31], s41 offen offset:768
    buffer_load_dwordx4 v[28:31], v10, s[28:31], s41 offen offset:832
    s_mov_b32 s41, 32768
    buffer_load_dwordx4 v[32:35], v10, s[28:31], s41 offen offset:768
    buffer_load_dwordx4 v[36:39], v10, s[28:31], s41 offen offset:832
    v_xor_b32 v254, 0, v7
    v_xor_b32 v255, 128, v7
    ds_read_b64_tr_b16 v[208:209], v254 offset:49152
    ds_read_b64_tr_b16 v[210:211], v255 offset:50176
    v_xor_b32 v254, 32, v7
    v_xor_b32 v255, 160, v7
    ds_read_b64_tr_b16 v[212:213], v254 offset:49152
    ds_read_b64_tr_b16 v[214:215], v255 offset:50176
    v_xor_b32 v254, 64, v7
    v_xor_b32 v255, 192, v7
    ds_read_b64_tr_b16 v[216:217], v254 offset:49152
    ds_read_b64_tr_b16 v[218:219], v255 offset:50176
    v_xor_b32 v254, 96, v7
    v_xor_b32 v255, 224, v7
    ds_read_b64_tr_b16 v[220:221], v254 offset:49152
    ds_read_b64_tr_b16 v[222:223], v255 offset:50176
    v_xor_b32 v254, 128, v7
    v_xor_b32 v255, 0, v7
    ds_read_b64_tr_b16 v[224:225], v254 offset:49152
    ds_read_b64_tr_b16 v[226:227], v255 offset:50176
    v_xor_b32 v254, 160, v7
    v_xor_b32 v255, 32, v7
    ds_read_b64_tr_b16 v[228:229], v254 offset:49152
    ds_read_b64_tr_b16 v[230:231], v255 offset:50176
    s_waitcnt lgkmcnt(10)
    v_mfma_f32_16x16x32_bf16 v[64:67], v[208:211], v[40:43], v[64:67]
    v_mfma_f32_16x16x32_bf16 v[68:71], v[208:211], v[48:51], v[68:71]
    v_mfma_f32_16x16x32_bf16 v[72:75], v[208:211], v[56:59], v[72:75]
    v_xor_b32 v254, 192, v7
    v_xor_b32 v255, 64, v7
    ds_read_b64_tr_b16 v[232:233], v254 offset:49152
    ds_read_b64_tr_b16 v[234:235], v255 offset:50176
    s_waitcnt lgkmcnt(10)
    v_mfma_f32_16x16x32_bf16 v[76:79], v[212:215], v[40:43], v[76:79]
    v_mfma_f32_16x16x32_bf16 v[80:83], v[212:215], v[48:51], v[80:83]
    v_mfma_f32_16x16x32_bf16 v[84:87], v[212:215], v[56:59], v[84:87]
    v_xor_b32 v254, 224, v7
    v_xor_b32 v255, 96, v7
    ds_read_b64_tr_b16 v[236:237], v254 offset:49152
    ds_read_b64_tr_b16 v[238:239], v255 offset:50176
    s_waitcnt lgkmcnt(10)
    v_mfma_f32_16x16x32_bf16 v[88:91], v[216:219], v[40:43], v[88:91]
    v_mfma_f32_16x16x32_bf16 v[92:95], v[216:219], v[48:51], v[92:95]
    v_mfma_f32_16x16x32_bf16 v[96:99], v[216:219], v[56:59], v[96:99]
    v_xor_b32 v254, 0, v7
    v_xor_b32 v255, 128, v7
    ds_read_b64_tr_b16 v[240:241], v254 offset:57344
    ds_read_b64_tr_b16 v[242:243], v255 offset:58368
    s_waitcnt lgkmcnt(10)
    v_mfma_f32_16x16x32_bf16 v[100:103], v[220:223], v[40:43], v[100:103]
    v_mfma_f32_16x16x32_bf16 v[104:107], v[220:223], v[48:51], v[104:107]
    v_mfma_f32_16x16x32_bf16 v[108:111], v[220:223], v[56:59], v[108:111]
    v_xor_b32 v254, 32, v7
    v_xor_b32 v255, 160, v7
    ds_read_b64_tr_b16 v[244:245], v254 offset:57344
    ds_read_b64_tr_b16 v[246:247], v255 offset:58368
    s_waitcnt lgkmcnt(10)
    v_mfma_f32_16x16x32_bf16 v[112:115], v[224:227], v[40:43], v[112:115]
    v_mfma_f32_16x16x32_bf16 v[116:119], v[224:227], v[48:51], v[116:119]
    v_mfma_f32_16x16x32_bf16 v[120:123], v[224:227], v[56:59], v[120:123]
    v_xor_b32 v254, 64, v7
    v_xor_b32 v255, 192, v7
    ds_read_b64_tr_b16 v[208:209], v254 offset:57344
    ds_read_b64_tr_b16 v[210:211], v255 offset:58368
    s_waitcnt lgkmcnt(10)
    v_mfma_f32_16x16x32_bf16 v[124:127], v[228:231], v[40:43], v[124:127]
    v_mfma_f32_16x16x32_bf16 v[128:131], v[228:231], v[48:51], v[128:131]
    v_mfma_f32_16x16x32_bf16 v[132:135], v[228:231], v[56:59], v[132:135]
    v_xor_b32 v254, 96, v7
    v_xor_b32 v255, 224, v7
    ds_read_b64_tr_b16 v[212:213], v254 offset:57344
    ds_read_b64_tr_b16 v[214:215], v255 offset:58368
    s_waitcnt lgkmcnt(10)
    v_mfma_f32_16x16x32_bf16 v[136:139], v[232:235], v[40:43], v[136:139]
    v_mfma_f32_16x16x32_bf16 v[140:143], v[232:235], v[48:51], v[140:143]
    v_mfma_f32_16x16x32_bf16 v[144:147], v[232:235], v[56:59], v[144:147]
    v_xor_b32 v254, 128, v7
    v_xor_b32 v255, 0, v7
    ds_read_b64_tr_b16 v[216:217], v254 offset:57344
    ds_read_b64_tr_b16 v[218:219], v255 offset:58368
    s_waitcnt lgkmcnt(10)
    v_mfma_f32_16x16x32_bf16 v[148:151], v[236:239], v[40:43], v[148:151]
    v_mfma_f32_16x16x32_bf16 v[152:155], v[236:239], v[48:51], v[152:155]
    v_mfma_f32_16x16x32_bf16 v[156:159], v[236:239], v[56:59], v[156:159]
    v_xor_b32 v254, 160, v7
    v_xor_b32 v255, 32, v7
    ds_read_b64_tr_b16 v[220:221], v254 offset:57344
    ds_read_b64_tr_b16 v[222:223], v255 offset:58368
    s_waitcnt lgkmcnt(10)
    v_mfma_f32_16x16x32_bf16 v[64:67], v[240:243], v[44:47], v[64:67]
    v_mfma_f32_16x16x32_bf16 v[68:71], v[240:243], v[52:55], v[68:71]
    v_mfma_f32_16x16x32_bf16 v[72:75], v[240:243], v[60:63], v[72:75]
    v_xor_b32 v254, 192, v7
    v_xor_b32 v255, 64, v7
    ds_read_b64_tr_b16 v[224:225], v254 offset:57344
    ds_read_b64_tr_b16 v[226:227], v255 offset:58368
    s_waitcnt lgkmcnt(10)
    v_mfma_f32_16x16x32_bf16 v[76:79], v[244:247], v[44:47], v[76:79]
    v_mfma_f32_16x16x32_bf16 v[80:83], v[244:247], v[52:55], v[80:83]
    v_mfma_f32_16x16x32_bf16 v[84:87], v[244:247], v[60:63], v[84:87]
    v_xor_b32 v254, 224, v7
    v_xor_b32 v255, 96, v7
    ds_read_b64_tr_b16 v[228:229], v254 offset:57344
    ds_read_b64_tr_b16 v[230:231], v255 offset:58368
    s_waitcnt lgkmcnt(10)
    v_mfma_f32_16x16x32_bf16 v[88:91], v[208:211], v[44:47], v[88:91]
    v_mfma_f32_16x16x32_bf16 v[92:95], v[208:211], v[52:55], v[92:95]
    v_mfma_f32_16x16x32_bf16 v[96:99], v[208:211], v[60:63], v[96:99]
    s_waitcnt lgkmcnt(8)
    v_mfma_f32_16x16x32_bf16 v[100:103], v[212:215], v[44:47], v[100:103]
    v_mfma_f32_16x16x32_bf16 v[104:107], v[212:215], v[52:55], v[104:107]
    v_mfma_f32_16x16x32_bf16 v[108:111], v[212:215], v[60:63], v[108:111]
    s_waitcnt lgkmcnt(6)
    v_mfma_f32_16x16x32_bf16 v[112:115], v[216:219], v[44:47], v[112:115]
    v_mfma_f32_16x16x32_bf16 v[116:119], v[216:219], v[52:55], v[116:119]
    v_mfma_f32_16x16x32_bf16 v[120:123], v[216:219], v[60:63], v[120:123]
    s_waitcnt lgkmcnt(4)
    v_mfma_f32_16x16x32_bf16 v[124:127], v[220:223], v[44:47], v[124:127]
    v_mfma_f32_16x16x32_bf16 v[128:131], v[220:223], v[52:55], v[128:131]
    v_mfma_f32_16x16x32_bf16 v[132:135], v[220:223], v[60:63], v[132:135]
    s_waitcnt lgkmcnt(2)
    v_mfma_f32_16x16x32_bf16 v[136:139], v[224:227], v[44:47], v[136:139]
    v_mfma_f32_16x16x32_bf16 v[140:143], v[224:227], v[52:55], v[140:143]
    v_mfma_f32_16x16x32_bf16 v[144:147], v[224:227], v[60:63], v[144:147]
    s_waitcnt lgkmcnt(0)
    v_mfma_f32_16x16x32_bf16 v[148:151], v[228:231], v[44:47], v[148:151]
    v_mfma_f32_16x16x32_bf16 v[152:155], v[228:231], v[52:55], v[152:155]
    v_mfma_f32_16x16x32_bf16 v[156:159], v[228:231], v[60:63], v[156:159]
    s_cmp_lg_u32 s3, 0
    s_cbranch_scc1 qw_4
    s_waitcnt vmcnt(24)
qw_4:
    s_cmp_eq_u32 s3, 0
    s_cbranch_scc1 qx_4
    s_waitcnt vmcnt(22)
qx_4:
    s_barrier
    s_add_u32 m0, s36, 49152
    s_lshl_b32 s40, s3, 15
    s_add_u32 s40, s40, 3670016
    buffer_load_dwordx4 v5, s[24:27], s40 offen lds
    s_add_u32 m0, s36, 52224
    s_lshl_b32 s40, s3, 15
    s_add_u32 s40, s40, 3768320
    buffer_load_dwordx4 v15, s[24:27], s40 offen lds
    s_add_u32 m0, s36, 55296
    s_lshl_b32 s40, s3, 15
    s_add_u32 s40, s40, 3866624
    buffer_load_dwordx4 v5, s[24:27], s40 offen lds
    s_add_u32 m0, s36, 58368
    s_lshl_b32 s40, s3, 15
    s_add_u32 s40, s40, 3964928
    buffer_load_dwordx4 v15, s[24:27], s40 offen lds
    s_add_u32 m0, s36, 61440
    s_lshl_b32 s40, s3, 15
    s_add_u32 s40, s40, 4063232
    buffer_load_dwordx4 v5, s[24:27], s40 offen lds
    s_cmp_lg_u32 s3, 0
    s_cbranch_scc1 wq_skip_7
    s_add_u32 m0, s36, 64512
    s_lshl_b32 s40, s3, 15
    s_add_u32 s40, s40, 4161536
    buffer_load_dwordx4 v15, s[24:27], s40 offen lds
wq_skip_7:
    s_mov_b32 s41, 0
    buffer_load_dwordx4 v[40:43], v10, s[28:31], s41 offen offset:896
    buffer_load_dwordx4 v[44:47], v10, s[28:31], s41 offen offset:960
    s_mov_b32 s41, 16384
    buffer_load_dwordx4 v[48:51], v10, s[28:31], s41 offen offset:896
    buffer_load_dwordx4 v[52:55], v10, s[28:31], s41 offen offset:960
    s_mov_b32 s41, 32768
    buffer_load_dwordx4 v[56:59], v10, s[28:31], s41 offen offset:896
    buffer_load_dwordx4 v[60:63], v10, s[28:31], s41 offen offset:960
    v_xor_b32 v254, 0, v7
    v_xor_b32 v255, 128, v7
    ds_read_b64_tr_b16 v[208:209], v254 offset:0
    ds_read_b64_tr_b16 v[210:211], v255 offset:1024
    v_xor_b32 v254, 32, v7
    v_xor_b32 v255, 160, v7
    ds_read_b64_tr_b16 v[212:213], v254 offset:0
    ds_read_b64_tr_b16 v[214:215], v255 offset:1024
    v_xor_b32 v254, 64, v7
    v_xor_b32 v255, 192, v7
    ds_read_b64_tr_b16 v[216:217], v254 offset:0
    ds_read_b64_tr_b16 v[218:219], v255 offset:1024
    v_xor_b32 v254, 96, v7
    v_xor_b32 v255, 224, v7
    ds_read_b64_tr_b16 v[220:221], v254 offset:0
    ds_read_b64_tr_b16 v[222:223], v255 offset:1024
    v_xor_b32 v254, 128, v7
    v_xor_b32 v255, 0, v7
    ds_read_b64_tr_b16 v[224:225], v254 offset:0
    ds_read_b64_tr_b16 v[226:227], v255 offset:1024
    v_xor_b32 v254, 160, v7
    v_xor_b32 v255, 32, v7
    ds_read_b64_tr_b16 v[228:229], v254 offset:0
    ds_read_b64_tr_b16 v[230:231], v255 offset:1024
    s_waitcnt lgkmcnt(10)
    v_mfma_f32_16x16x32_bf16 v[64:67], v[208:211], v[160:163], v[64:67]
    v_mfma_f32_16x16x32_bf16 v[68:71], v[208:211], v[168:171], v[68:71]
    v_mfma_f32_16x16x32_bf16 v[72:75], v[208:211], v[176:179], v[72:75]
    v_xor_b32 v254, 192, v7
    v_xor_b32 v255, 64, v7
    ds_read_b64_tr_b16 v[232:233], v254 offset:0
    ds_read_b64_tr_b16 v[234:235], v255 offset:1024
    s_waitcnt lgkmcnt(10)
    v_mfma_f32_16x16x32_bf16 v[76:79], v[212:215], v[160:163], v[76:79]
    v_mfma_f32_16x16x32_bf16 v[80:83], v[212:215], v[168:171], v[80:83]
    v_mfma_f32_16x16x32_bf16 v[84:87], v[212:215], v[176:179], v[84:87]
    v_xor_b32 v254, 224, v7
    v_xor_b32 v255, 96, v7
    ds_read_b64_tr_b16 v[236:237], v254 offset:0
    ds_read_b64_tr_b16 v[238:239], v255 offset:1024
    s_waitcnt lgkmcnt(10)
    v_mfma_f32_16x16x32_bf16 v[88:91], v[216:219], v[160:163], v[88:91]
    v_mfma_f32_16x16x32_bf16 v[92:95], v[216:219], v[168:171], v[92:95]
    v_mfma_f32_16x16x32_bf16 v[96:99], v[216:219], v[176:179], v[96:99]
    v_xor_b32 v254, 0, v7
    v_xor_b32 v255, 128, v7
    ds_read_b64_tr_b16 v[240:241], v254 offset:8192
    ds_read_b64_tr_b16 v[242:243], v255 offset:9216
    s_waitcnt lgkmcnt(10)
    v_mfma_f32_16x16x32_bf16 v[100:103], v[220:223], v[160:163], v[100:103]
    v_mfma_f32_16x16x32_bf16 v[104:107], v[220:223], v[168:171], v[104:107]
    v_mfma_f32_16x16x32_bf16 v[108:111], v[220:223], v[176:179], v[108:111]
    v_xor_b32 v254, 32, v7
    v_xor_b32 v255, 160, v7
    ds_read_b64_tr_b16 v[244:245], v254 offset:8192
    ds_read_b64_tr_b16 v[246:247], v255 offset:9216
    s_waitcnt lgkmcnt(10)
    v_mfma_f32_16x16x32_bf16 v[112:115], v[224:227], v[160:163], v[112:115]
    v_mfma_f32_16x16x32_bf16 v[116:119], v[224:227], v[168:171], v[116:119]
    v_mfma_f32_16x16x32_bf16 v[120:123], v[224:227], v[176:179], v[120:123]
    v_xor_b32 v254, 64, v7
    v_xor_b32 v255, 192, v7
    ds_read_b64_tr_b16 v[208:209], v254 offset:8192
    ds_read_b64_tr_b16 v[210:211], v255 offset:9216
    s_waitcnt lgkmcnt(10)
    v_mfma_f32_16x16x32_bf16 v[124:127], v[228:231], v[160:163], v[124:127]
    v_mfma_f32_16x16x32_bf16 v[128:131], v[228:231], v[168:171], v[128:131]
    v_mfma_f32_16x16x32_bf16 v[132:135], v[228:231], v[176:179], v[132:135]
    v_xor_b32 v254, 96, v7
    v_xor_b32 v255, 224, v7
    ds_read_b64_tr_b16 v[212:213], v254 offset:8192
    ds_read_b64_tr_b16 v[214:215], v255 offset:9216
    s_waitcnt lgkmcnt(10)
    v_mfma_f32_16x16x32_bf16 v[136:139], v[232:235], v[160:163], v[136:139]
    v_mfma_f32_16x16x32_bf16 v[140:143], v[232:235], v[168:171], v[140:143]
    v_mfma_f32_16x16x32_bf16 v[144:147], v[232:235], v[176:179], v[144:147]
    v_xor_b32 v254, 128, v7
    v_xor_b32 v255, 0, v7
    ds_read_b64_tr_b16 v[216:217], v254 offset:8192
    ds_read_b64_tr_b16 v[218:219], v255 offset:9216
    s_waitcnt lgkmcnt(10)
    v_mfma_f32_16x16x32_bf16 v[148:151], v[236:239], v[160:163], v[148:151]
    v_mfma_f32_16x16x32_bf16 v[152:155], v[236:239], v[168:171], v[152:155]
    v_mfma_f32_16x16x32_bf16 v[156:159], v[236:239], v[176:179], v[156:159]
    v_xor_b32 v254, 160, v7
    v_xor_b32 v255, 32, v7
    ds_read_b64_tr_b16 v[220:221], v254 offset:8192
    ds_read_b64_tr_b16 v[222:223], v255 offset:9216
    s_waitcnt lgkmcnt(10)
    v_mfma_f32_16x16x32_bf16 v[64:67], v[240:243], v[164:167], v[64:67]
    v_mfma_f32_16x16x32_bf16 v[68:71], v[240:243], v[172:175], v[68:71]
    v_mfma_f32_16x16x32_bf16 v[72:75], v[240:243], v[180:183], v[72:75]
    v_xor_b32 v254, 192, v7
    v_xor_b32 v255, 64, v7
    ds_read_b64_tr_b16 v[224:225], v254 offset:8192
    ds_read_b64_tr_b16 v[226:227], v255 offset:9216
    s_waitcnt lgkmcnt(10)
    v_mfma_f32_16x16x32_bf16 v[76:79], v[244:247], v[164:167], v[76:79]
    v_mfma_f32_16x16x32_bf16 v[80:83], v[244:247], v[172:175], v[80:83]
    v_mfma_f32_16x16x32_bf16 v[84:87], v[244:247], v[180:183], v[84:87]
    v_xor_b32 v254, 224, v7
    v_xor_b32 v255, 96, v7
    ds_read_b64_tr_b16 v[228:229], v254 offset:8192
    ds_read_b64_tr_b16 v[230:231], v255 offset:9216
    s_waitcnt lgkmcnt(10)
    v_mfma_f32_16x16x32_bf16 v[88:91], v[208:211], v[164:167], v[88:91]
    v_mfma_f32_16x16x32_bf16 v[92:95], v[208:211], v[172:175], v[92:95]
    v_mfma_f32_16x16x32_bf16 v[96:99], v[208:211], v[180:183], v[96:99]
    s_waitcnt lgkmcnt(8)
    v_mfma_f32_16x16x32_bf16 v[100:103], v[212:215], v[164:167], v[100:103]
    v_mfma_f32_16x16x32_bf16 v[104:107], v[212:215], v[172:175], v[104:107]
    v_mfma_f32_16x16x32_bf16 v[108:111], v[212:215], v[180:183], v[108:111]
    s_waitcnt lgkmcnt(6)
    v_mfma_f32_16x16x32_bf16 v[112:115], v[216:219], v[164:167], v[112:115]
    v_mfma_f32_16x16x32_bf16 v[116:119], v[216:219], v[172:175], v[116:119]
    v_mfma_f32_16x16x32_bf16 v[120:123], v[216:219], v[180:183], v[120:123]
    s_waitcnt lgkmcnt(4)
    v_mfma_f32_16x16x32_bf16 v[124:127], v[220:223], v[164:167], v[124:127]
    v_mfma_f32_16x16x32_bf16 v[128:131], v[220:223], v[172:175], v[128:131]
    v_mfma_f32_16x16x32_bf16 v[132:135], v[220:223], v[180:183], v[132:135]
    s_waitcnt lgkmcnt(2)
    v_mfma_f32_16x16x32_bf16 v[136:139], v[224:227], v[164:167], v[136:139]
    v_mfma_f32_16x16x32_bf16 v[140:143], v[224:227], v[172:175], v[140:143]
    v_mfma_f32_16x16x32_bf16 v[144:147], v[224:227], v[180:183], v[144:147]
    s_waitcnt lgkmcnt(0)
    v_mfma_f32_16x16x32_bf16 v[148:151], v[228:231], v[164:167], v[148:151]
    v_mfma_f32_16x16x32_bf16 v[152:155], v[228:231], v[172:175], v[152:155]
    v_mfma_f32_16x16x32_bf16 v[156:159], v[228:231], v[180:183], v[156:159]
    s_cmp_lg_u32 s3, 0
    s_cbranch_scc1 qw_5
    s_waitcnt vmcnt(24)
qw_5:
    s_cmp_eq_u32 s3, 0
    s_cbranch_scc1 qx_5
    s_waitcnt vmcnt(22)
qx_5:
    s_barrier
    v_xor_b32 v254, 0, v7
    v_xor_b32 v255, 128, v7
    ds_read_b64_tr_b16 v[208:209], v254 offset:16384
    ds_read_b64_tr_b16 v[210:211], v255 offset:17408
    v_xor_b32 v254, 32, v7
    v_xor_b32 v255, 160, v7
    ds_read_b64_tr_b16 v[212:213], v254 offset:16384
    ds_read_b64_tr_b16 v[214:215], v255 offset:17408
    v_xor_b32 v254, 64, v7
    v_xor_b32 v255, 192, v7
    ds_read_b64_tr_b16 v[216:217], v254 offset:16384
    ds_read_b64_tr_b16 v[218:219], v255 offset:17408
    v_xor_b32 v254, 96, v7
    v_xor_b32 v255, 224, v7
    ds_read_b64_tr_b16 v[220:221], v254 offset:16384
    ds_read_b64_tr_b16 v[222:223], v255 offset:17408
    v_xor_b32 v254, 128, v7
    v_xor_b32 v255, 0, v7
    ds_read_b64_tr_b16 v[224:225], v254 offset:16384
    ds_read_b64_tr_b16 v[226:227], v255 offset:17408
    v_xor_b32 v254, 160, v7
    v_xor_b32 v255, 32, v7
    ds_read_b64_tr_b16 v[228:229], v254 offset:16384
    ds_read_b64_tr_b16 v[230:231], v255 offset:17408
    s_waitcnt lgkmcnt(10)
    v_mfma_f32_16x16x32_bf16 v[64:67], v[208:211], v[184:187], v[64:67]
    v_mfma_f32_16x16x32_bf16 v[68:71], v[208:211], v[192:195], v[68:71]
    v_mfma_f32_16x16x32_bf16 v[72:75], v[208:211], v[200:203], v[72:75]
    v_xor_b32 v254, 192, v7
    v_xor_b32 v255, 64, v7
    ds_read_b64_tr_b16 v[232:233], v254 offset:16384
    ds_read_b64_tr_b16 v[234:235], v255 offset:17408
    s_waitcnt lgkmcnt(10)
    v_mfma_f32_16x16x32_bf16 v[76:79], v[212:215], v[184:187], v[76:79]
    v_mfma_f32_16x16x32_bf16 v[80:83], v[212:215], v[192:195], v[80:83]
    v_mfma_f32_16x16x32_bf16 v[84:87], v[212:215], v[200:203], v[84:87]
    v_xor_b32 v254, 224, v7
    v_xor_b32 v255, 96, v7
    ds_read_b64_tr_b16 v[236:237], v254 offset:16384
    ds_read_b64_tr_b16 v[238:239], v255 offset:17408
    s_waitcnt lgkmcnt(10)
    v_mfma_f32_16x16x32_bf16 v[88:91], v[216:219], v[184:187], v[88:91]
    v_mfma_f32_16x16x32_bf16 v[92:95], v[216:219], v[192:195], v[92:95]
    v_mfma_f32_16x16x32_bf16 v[96:99], v[216:219], v[200:203], v[96:99]
    v_xor_b32 v254, 0, v7
    v_xor_b32 v255, 128, v7
    ds_read_b64_tr_b16 v[240:241], v254 offset:24576
    ds_read_b64_tr_b16 v[242:243], v255 offset:25600
    s_waitcnt lgkmcnt(10)
    v_mfma_f32_16x16x32_bf16 v[100:103], v[220:223], v[184:187], v[100:103]
    v_mfma_f32_16x16x32_bf16 v[104:107], v[220:223], v[192:195], v[104:107]
    v_mfma_f32_16x16x32_bf16 v[108:111], v[220:223], v[200:203], v[108:111]
    v_xor_b32 v254, 32, v7
    v_xor_b32 v255, 160, v7
    ds_read_b64_tr_b16 v[244:245], v254 offset:24576
    ds_read_b64_tr_b16 v[246:247], v255 offset:25600
    s_waitcnt lgkmcnt(10)
    v_mfma_f32_16x16x32_bf16 v[112:115], v[224:227], v[184:187], v[112:115]
    v_mfma_f32_16x16x32_bf16 v[116:119], v[224:227], v[192:195], v[116:119]
    v_mfma_f32_16x16x32_bf16 v[120:123], v[224:227], v[200:203], v[120:123]
    v_xor_b32 v254, 64, v7
    v_xor_b32 v255, 192, v7
    ds_read_b64_tr_b16 v[208:209], v254 offset:24576
    ds_read_b64_tr_b16 v[210:211], v255 offset:25600
    s_waitcnt lgkmcnt(10)
    v_mfma_f32_16x16x32_bf16 v[124:127], v[228:231], v[184:187], v[124:127]
    v_mfma_f32_16x16x32_bf16 v[128:131], v[228:231], v[192:195], v[128:131]
    v_mfma_f32_16x16x32_bf16 v[132:135], v[228:231], v[200:203], v[132:135]
    v_xor_b32 v254, 96, v7
    v_xor_b32 v255, 224, v7
    ds_read_b64_tr_b16 v[212:213], v254 offset:24576
    ds_read_b64_tr_b16 v[214:215], v255 offset:25600
    s_waitcnt lgkmcnt(10)
    v_mfma_f32_16x16x32_bf16 v[136:139], v[232:235], v[184:187], v[136:139]
    v_mfma_f32_16x16x32_bf16 v[140:143], v[232:235], v[192:195], v[140:143]
    v_mfma_f32_16x16x32_bf16 v[144:147], v[232:235], v[200:203], v[144:147]
    v_xor_b32 v254, 128, v7
    v_xor_b32 v255, 0, v7
    ds_read_b64_tr_b16 v[216:217], v254 offset:24576
    ds_read_b64_tr_b16 v[218:219], v255 offset:25600
    s_waitcnt lgkmcnt(10)
    v_mfma_f32_16x16x32_bf16 v[148:151], v[236:239], v[184:187], v[148:151]
    v_mfma_f32_16x16x32_bf16 v[152:155], v[236:239], v[192:195], v[152:155]
    v_mfma_f32_16x16x32_bf16 v[156:159], v[236:239], v[200:203], v[156:159]
    v_xor_b32 v254, 160, v7
    v_xor_b32 v255, 32, v7
    ds_read_b64_tr_b16 v[220:221], v254 offset:24576
    ds_read_b64_tr_b16 v[222:223], v255 offset:25600
    s_waitcnt lgkmcnt(10)
    v_mfma_f32_16x16x32_bf16 v[64:67], v[240:243], v[188:191], v[64:67]
    v_mfma_f32_16x16x32_bf16 v[68:71], v[240:243], v[196:199], v[68:71]
    v_mfma_f32_16x16x32_bf16 v[72:75], v[240:243], v[204:207], v[72:75]
    v_xor_b32 v254, 192, v7
    v_xor_b32 v255, 64, v7
    ds_read_b64_tr_b16 v[224:225], v254 offset:24576
    ds_read_b64_tr_b16 v[226:227], v255 offset:25600
    s_waitcnt lgkmcnt(10)
    v_mfma_f32_16x16x32_bf16 v[76:79], v[244:247], v[188:191], v[76:79]
    v_mfma_f32_16x16x32_bf16 v[80:83], v[244:247], v[196:199], v[80:83]
    v_mfma_f32_16x16x32_bf16 v[84:87], v[244:247], v[204:207], v[84:87]
    v_xor_b32 v254, 224, v7
    v_xor_b32 v255, 96, v7
    ds_read_b64_tr_b16 v[228:229], v254 offset:24576
    ds_read_b64_tr_b16 v[230:231], v255 offset:25600
    s_waitcnt lgkmcnt(10)
    v_mfma_f32_16x16x32_bf16 v[88:91], v[208:211], v[188:191], v[88:91]
    v_mfma_f32_16x16x32_bf16 v[92:95], v[208:211], v[196:199], v[92:95]
    v_mfma_f32_16x16x32_bf16 v[96:99], v[208:211], v[204:207], v[96:99]
    s_waitcnt lgkmcnt(8)
    v_mfma_f32_16x16x32_bf16 v[100:103], v[212:215], v[188:191], v[100:103]
    v_mfma_f32_16x16x32_bf16 v[104:107], v[212:215], v[196:199], v[104:107]
    v_mfma_f32_16x16x32_bf16 v[108:111], v[212:215], v[204:207], v[108:111]
    s_waitcnt lgkmcnt(6)
    v_mfma_f32_16x16x32_bf16 v[112:115], v[216:219], v[188:191], v[112:115]
    v_mfma_f32_16x16x32_bf16 v[116:119], v[216:219], v[196:199], v[116:119]
    v_mfma_f32_16x16x32_bf16 v[120:123], v[216:219], v[204:207], v[120:123]
    s_waitcnt lgkmcnt(4)
    v_mfma_f32_16x16x32_bf16 v[124:127], v[220:223], v[188:191], v[124:127]
    v_mfma_f32_16x16x32_bf16 v[128:131], v[220:223], v[196:199], v[128:131]
    v_mfma_f32_16x16x32_bf16 v[132:135], v[220:223], v[204:207], v[132:135]
    s_waitcnt lgkmcnt(2)
    v_mfma_f32_16x16x32_bf16 v[136:139], v[224:227], v[188:191], v[136:139]
    v_mfma_f32_16x16x32_bf16 v[140:143], v[224:227], v[196:199], v[140:143]
    v_mfma_f32_16x16x32_bf16 v[144:147], v[224:227], v[204:207], v[144:147]
    s_waitcnt lgkmcnt(0)
    v_mfma_f32_16x16x32_bf16 v[148:151], v[228:231], v[188:191], v[148:151]
    v_mfma_f32_16x16x32_bf16 v[152:155], v[228:231], v[196:199], v[152:155]
    v_mfma_f32_16x16x32_bf16 v[156:159], v[228:231], v[204:207], v[156:159]
    s_waitcnt vmcnt(0)
    s_barrier
    s_mov_b32 s42, 0
    s_mov_b32 s43, 0
    s_add_u32 s40, s36, 0
    s_add_u32 m0, s40, s42
    s_add_u32 s40, s40, s43
    buffer_load_dwordx4 v4, s[16:19], s40 offen lds
    s_add_u32 s40, s36, 3072
    s_add_u32 m0, s40, s42
    s_add_u32 s40, s40, s43
    buffer_load_dwordx4 v14, s[16:19], s40 offen lds
    s_add_u32 s40, s36, 6144
    s_add_u32 m0, s40, s42
    s_add_u32 s40, s40, s43
    buffer_load_dwordx4 v4, s[16:19], s40 offen lds
    s_add_u32 s40, s36, 9216
    s_add_u32 m0, s40, s42
    s_add_u32 s40, s40, s43
    buffer_load_dwordx4 v14, s[16:19], s40 offen lds
    s_add_u32 s40, s36, 12288
    s_add_u32 m0, s40, s42
    s_add_u32 s40, s40, s43
    buffer_load_dwordx4 v4, s[16:19], s40 offen lds
    s_cmp_lg_u32 s3, 0
    s_cbranch_scc1 kskip_pre
    s_add_u32 s40, s36, 15360
    s_add_u32 m0, s40, s42
    s_add_u32 s40, s40, s43
    buffer_load_dwordx4 v14, s[16:19], s40 offen lds
kskip_pre:
    s_add_u32 s40, s37, 0
    s_add_u32 m0, s40, s42
    s_add_u32 m0, m0, 0x4000
    s_add_u32 s40, s40, s43
    buffer_load_dwordx4 v4, s[20:23], s40 offen lds
    s_add_u32 s40, s37, 3072
    s_add_u32 m0, s40, s42
    s_add_u32 m0, m0, 0x4000
    s_add_u32 s40, s40, s43
    buffer_load_dwordx4 v14, s[20:23], s40 offen lds
    s_add_u32 s40, s37, 6144
    s_add_u32 m0, s40, s42
    s_add_u32 m0, m0, 0x4000
    s_add_u32 s40, s40, s43
    buffer_load_dwordx4 v4, s[20:23], s40 offen lds
    s_add_u32 s40, s37, 9216
    s_add_u32 m0, s40, s42
    s_add_u32 m0, m0, 0x4000
    s_add_u32 s40, s40, s43
    buffer_load_dwordx4 v14, s[20:23], s40 offen lds
    s_add_u32 s40, s37, 12288
    s_add_u32 m0, s40, s42
    s_add_u32 m0, m0, 0x4000
    s_add_u32 s40, s40, s43
    buffer_load_dwordx4 v4, s[20:23], s40 offen lds
    s_cmp_lg_u32 s3, 2
    s_cbranch_scc1 vskip_pre
    s_add_u32 s40, s37, 15360
    s_add_u32 m0, s40, s42
    s_add_u32 m0, m0, 0x4000
    s_add_u32 s40, s40, s43
    buffer_load_dwordx4 v14, s[20:23], s40 offen lds
vskip_pre:
    v_xor_b32 v254, 0, v7
    v_xor_b32 v255, 128, v7
    ds_read_b64_tr_b16 v[208:209], v254 offset:32768
    ds_read_b64_tr_b16 v[210:211], v255 offset:33792
    v_xor_b32 v254, 32, v7
    v_xor_b32 v255, 160, v7
    ds_read_b64_tr_b16 v[212:213], v254 offset:32768
    ds_read_b64_tr_b16 v[214:215], v255 offset:33792
    v_xor_b32 v254, 64, v7
    v_xor_b32 v255, 192, v7
    ds_read_b64_tr_b16 v[216:217], v254 offset:32768
    ds_read_b64_tr_b16 v[218:219], v255 offset:33792
    v_xor_b32 v254, 96, v7
    v_xor_b32 v255, 224, v7
    ds_read_b64_tr_b16 v[220:221], v254 offset:32768
    ds_read_b64_tr_b16 v[222:223], v255 offset:33792
    v_xor_b32 v254, 128, v7
    v_xor_b32 v255, 0, v7
    ds_read_b64_tr_b16 v[224:225], v254 offset:32768
    ds_read_b64_tr_b16 v[226:227], v255 offset:33792
    v_xor_b32 v254, 160, v7
    v_xor_b32 v255, 32, v7
    ds_read_b64_tr_b16 v[228:229], v254 offset:32768
    ds_read_b64_tr_b16 v[230:231], v255 offset:33792
    s_waitcnt lgkmcnt(10)
    v_mfma_f32_16x16x32_bf16 v[64:67], v[208:211], v[16:19], v[64:67]
    v_mfma_f32_16x16x32_bf16 v[68:71], v[208:211], v[24:27], v[68:71]
    v_mfma_f32_16x16x32_bf16 v[72:75], v[208:211], v[32:35], v[72:75]
    v_xor_b32 v254, 192, v7
    v_xor_b32 v255, 64, v7
    ds_read_b64_tr_b16 v[232:233], v254 offset:32768
    ds_read_b64_tr_b16 v[234:235], v255 offset:33792
    s_waitcnt lgkmcnt(10)
    v_mfma_f32_16x16x32_bf16 v[76:79], v[212:215], v[16:19], v[76:79]
    v_mfma_f32_16x16x32_bf16 v[80:83], v[212:215], v[24:27], v[80:83]
    v_mfma_f32_16x16x32_bf16 v[84:87], v[212:215], v[32:35], v[84:87]
    v_xor_b32 v254, 224, v7
    v_xor_b32 v255, 96, v7
    ds_read_b64_tr_b16 v[236:237], v254 offset:32768
    ds_read_b64_tr_b16 v[238:239], v255 offset:33792
    s_waitcnt lgkmcnt(10)
    v_mfma_f32_16x16x32_bf16 v[88:91], v[216:219], v[16:19], v[88:91]
    v_mfma_f32_16x16x32_bf16 v[92:95], v[216:219], v[24:27], v[92:95]
    v_mfma_f32_16x16x32_bf16 v[96:99], v[216:219], v[32:35], v[96:99]
    v_xor_b32 v254, 0, v7
    v_xor_b32 v255, 128, v7
    ds_read_b64_tr_b16 v[240:241], v254 offset:40960
    ds_read_b64_tr_b16 v[242:243], v255 offset:41984
    s_waitcnt lgkmcnt(10)
    v_mfma_f32_16x16x32_bf16 v[100:103], v[220:223], v[16:19], v[100:103]
    v_mfma_f32_16x16x32_bf16 v[104:107], v[220:223], v[24:27], v[104:107]
    v_mfma_f32_16x16x32_bf16 v[108:111], v[220:223], v[32:35], v[108:111]
    v_xor_b32 v254, 32, v7
    v_xor_b32 v255, 160, v7
    ds_read_b64_tr_b16 v[244:245], v254 offset:40960
    ds_read_b64_tr_b16 v[246:247], v255 offset:41984
    s_waitcnt lgkmcnt(10)
    v_mfma_f32_16x16x32_bf16 v[112:115], v[224:227], v[16:19], v[112:115]
    v_mfma_f32_16x16x32_bf16 v[116:119], v[224:227], v[24:27], v[116:119]
    v_mfma_f32_16x16x32_bf16 v[120:123], v[224:227], v[32:35], v[120:123]
    v_xor_b32 v254, 64, v7
    v_xor_b32 v255, 192, v7
    ds_read_b64_tr_b16 v[208:209], v254 offset:40960
    ds_read_b64_tr_b16 v[210:211], v255 offset:41984
    s_waitcnt lgkmcnt(10)
    v_mfma_f32_16x16x32_bf16 v[124:127], v[228:231], v[16:19], v[124:127]
    v_mfma_f32_16x16x32_bf16 v[128:131], v[228:231], v[24:27], v[128:131]
    v_mfma_f32_16x16x32_bf16 v[132:135], v[228:231], v[32:35], v[132:135]
    v_xor_b32 v254, 96, v7
    v_xor_b32 v255, 224, v7
    ds_read_b64_tr_b16 v[212:213], v254 offset:40960
    ds_read_b64_tr_b16 v[214:215], v255 offset:41984
    s_waitcnt lgkmcnt(10)
    v_mfma_f32_16x16x32_bf16 v[136:139], v[232:235], v[16:19], v[136:139]
    v_mfma_f32_16x16x32_bf16 v[140:143], v[232:235], v[24:27], v[140:143]
    v_mfma_f32_16x16x32_bf16 v[144:147], v[232:235], v[32:35], v[144:147]
    v_xor_b32 v254, 128, v7
    v_xor_b32 v255, 0, v7
    ds_read_b64_tr_b16 v[216:217], v254 offset:40960
    ds_read_b64_tr_b16 v[218:219], v255 offset:41984
    s_waitcnt lgkmcnt(10)
    v_mfma_f32_16x16x32_bf16 v[148:151], v[236:239], v[16:19], v[148:151]
    v_mfma_f32_16x16x32_bf16 v[152:155], v[236:239], v[24:27], v[152:155]
    v_mfma_f32_16x16x32_bf16 v[156:159], v[236:239], v[32:35], v[156:159]
    v_xor_b32 v254, 160, v7
    v_xor_b32 v255, 32, v7
    ds_read_b64_tr_b16 v[220:221], v254 offset:40960
    ds_read_b64_tr_b16 v[222:223], v255 offset:41984
    s_waitcnt lgkmcnt(10)
    v_mfma_f32_16x16x32_bf16 v[64:67], v[240:243], v[20:23], v[64:67]
    v_mfma_f32_16x16x32_bf16 v[68:71], v[240:243], v[28:31], v[68:71]
    v_mfma_f32_16x16x32_bf16 v[72:75], v[240:243], v[36:39], v[72:75]
    v_xor_b32 v254, 192, v7
    v_xor_b32 v255, 64, v7
    ds_read_b64_tr_b16 v[224:225], v254 offset:40960
    ds_read_b64_tr_b16 v[226:227], v255 offset:41984
    s_waitcnt lgkmcnt(10)
    v_mfma_f32_16x16x32_bf16 v[76:79], v[244:247], v[20:23], v[76:79]
    v_mfma_f32_16x16x32_bf16 v[80:83], v[244:247], v[28:31], v[80:83]
    v_mfma_f32_16x16x32_bf16 v[84:87], v[244:247], v[36:39], v[84:87]
    v_xor_b32 v254, 224, v7
    v_xor_b32 v255, 96, v7
    ds_read_b64_tr_b16 v[228:229], v254 offset:40960
    ds_read_b64_tr_b16 v[230:231], v255 offset:41984
    s_waitcnt lgkmcnt(10)
    v_mfma_f32_16x16x32_bf16 v[88:91], v[208:211], v[20:23], v[88:91]
    v_mfma_f32_16x16x32_bf16 v[92:95], v[208:211], v[28:31], v[92:95]
    v_mfma_f32_16x16x32_bf16 v[96:99], v[208:211], v[36:39], v[96:99]
    s_waitcnt lgkmcnt(8)
    v_mfma_f32_16x16x32_bf16 v[100:103], v[212:215], v[20:23], v[100:103]
    v_mfma_f32_16x16x32_bf16 v[104:107], v[212:215], v[28:31], v[104:107]
    v_mfma_f32_16x16x32_bf16 v[108:111], v[212:215], v[36:39], v[108:111]
    s_waitcnt lgkmcnt(6)
    v_mfma_f32_16x16x32_bf16 v[112:115], v[216:219], v[20:23], v[112:115]
    v_mfma_f32_16x16x32_bf16 v[116:119], v[216:219], v[28:31], v[116:119]
    v_mfma_f32_16x16x32_bf16 v[120:123], v[216:219], v[36:39], v[120:123]
    s_waitcnt lgkmcnt(4)
    v_mfma_f32_16x16x32_bf16 v[124:127], v[220:223], v[20:23], v[124:127]
    v_mfma_f32_16x16x32_bf16 v[128:131], v[220:223], v[28:31], v[128:131]
    v_mfma_f32_16x16x32_bf16 v[132:135], v[220:223], v[36:39], v[132:135]
    s_waitcnt lgkmcnt(2)
    v_mfma_f32_16x16x32_bf16 v[136:139], v[224:227], v[20:23], v[136:139]
    v_mfma_f32_16x16x32_bf16 v[140:143], v[224:227], v[28:31], v[140:143]
    v_mfma_f32_16x16x32_bf16 v[144:147], v[224:227], v[36:39], v[144:147]
    s_waitcnt lgkmcnt(0)
    v_mfma_f32_16x16x32_bf16 v[148:151], v[228:231], v[20:23], v[148:151]
    v_mfma_f32_16x16x32_bf16 v[152:155], v[228:231], v[28:31], v[152:155]
    v_mfma_f32_16x16x32_bf16 v[156:159], v[228:231], v[36:39], v[156:159]
    s_waitcnt vmcnt(0)
    s_barrier
    v_xor_b32 v254, 0, v7
    v_xor_b32 v255, 128, v7
    ds_read_b64_tr_b16 v[208:209], v254 offset:49152
    ds_read_b64_tr_b16 v[210:211], v255 offset:50176
    v_xor_b32 v254, 32, v7
    v_xor_b32 v255, 160, v7
    ds_read_b64_tr_b16 v[212:213], v254 offset:49152
    ds_read_b64_tr_b16 v[214:215], v255 offset:50176
    v_xor_b32 v254, 64, v7
    v_xor_b32 v255, 192, v7
    ds_read_b64_tr_b16 v[216:217], v254 offset:49152
    ds_read_b64_tr_b16 v[218:219], v255 offset:50176
    v_xor_b32 v254, 96, v7
    v_xor_b32 v255, 224, v7
    ds_read_b64_tr_b16 v[220:221], v254 offset:49152
    ds_read_b64_tr_b16 v[222:223], v255 offset:50176
    v_xor_b32 v254, 128, v7
    v_xor_b32 v255, 0, v7
    ds_read_b64_tr_b16 v[224:225], v254 offset:49152
    ds_read_b64_tr_b16 v[226:227], v255 offset:50176
    v_xor_b32 v254, 160, v7
    v_xor_b32 v255, 32, v7
    ds_read_b64_tr_b16 v[228:229], v254 offset:49152
    ds_read_b64_tr_b16 v[230:231], v255 offset:50176
    s_waitcnt lgkmcnt(10)
    v_mfma_f32_16x16x32_bf16 v[64:67], v[208:211], v[40:43], v[64:67]
    v_mfma_f32_16x16x32_bf16 v[68:71], v[208:211], v[48:51], v[68:71]
    v_mfma_f32_16x16x32_bf16 v[72:75], v[208:211], v[56:59], v[72:75]
    v_xor_b32 v254, 192, v7
    v_xor_b32 v255, 64, v7
    ds_read_b64_tr_b16 v[232:233], v254 offset:49152
    ds_read_b64_tr_b16 v[234:235], v255 offset:50176
    s_waitcnt lgkmcnt(10)
    v_mfma_f32_16x16x32_bf16 v[76:79], v[212:215], v[40:43], v[76:79]
    v_mfma_f32_16x16x32_bf16 v[80:83], v[212:215], v[48:51], v[80:83]
    v_mfma_f32_16x16x32_bf16 v[84:87], v[212:215], v[56:59], v[84:87]
    v_xor_b32 v254, 224, v7
    v_xor_b32 v255, 96, v7
    ds_read_b64_tr_b16 v[236:237], v254 offset:49152
    ds_read_b64_tr_b16 v[238:239], v255 offset:50176
    s_waitcnt lgkmcnt(10)
    v_mfma_f32_16x16x32_bf16 v[88:91], v[216:219], v[40:43], v[88:91]
    v_mfma_f32_16x16x32_bf16 v[92:95], v[216:219], v[48:51], v[92:95]
    v_mfma_f32_16x16x32_bf16 v[96:99], v[216:219], v[56:59], v[96:99]
    v_xor_b32 v254, 0, v7
    v_xor_b32 v255, 128, v7
    ds_read_b64_tr_b16 v[240:241], v254 offset:57344
    ds_read_b64_tr_b16 v[242:243], v255 offset:58368
    s_waitcnt lgkmcnt(10)
    v_mfma_f32_16x16x32_bf16 v[100:103], v[220:223], v[40:43], v[100:103]
    v_mfma_f32_16x16x32_bf16 v[104:107], v[220:223], v[48:51], v[104:107]
    v_mfma_f32_16x16x32_bf16 v[108:111], v[220:223], v[56:59], v[108:111]
    v_xor_b32 v254, 32, v7
    v_xor_b32 v255, 160, v7
    ds_read_b64_tr_b16 v[244:245], v254 offset:57344
    ds_read_b64_tr_b16 v[246:247], v255 offset:58368
    s_waitcnt lgkmcnt(10)
    v_mfma_f32_16x16x32_bf16 v[112:115], v[224:227], v[40:43], v[112:115]
    v_mfma_f32_16x16x32_bf16 v[116:119], v[224:227], v[48:51], v[116:119]
    v_mfma_f32_16x16x32_bf16 v[120:123], v[224:227], v[56:59], v[120:123]
    v_xor_b32 v254, 64, v7
    v_xor_b32 v255, 192, v7
    ds_read_b64_tr_b16 v[208:209], v254 offset:57344
    ds_read_b64_tr_b16 v[210:211], v255 offset:58368
    s_waitcnt lgkmcnt(10)
    v_mfma_f32_16x16x32_bf16 v[124:127], v[228:231], v[40:43], v[124:127]
    v_mfma_f32_16x16x32_bf16 v[128:131], v[228:231], v[48:51], v[128:131]
    v_mfma_f32_16x16x32_bf16 v[132:135], v[228:231], v[56:59], v[132:135]
    v_xor_b32 v254, 96, v7
    v_xor_b32 v255, 224, v7
    ds_read_b64_tr_b16 v[212:213], v254 offset:57344
    ds_read_b64_tr_b16 v[214:215], v255 offset:58368
    s_waitcnt lgkmcnt(10)
    v_mfma_f32_16x16x32_bf16 v[136:139], v[232:235], v[40:43], v[136:139]
    v_mfma_f32_16x16x32_bf16 v[140:143], v[232:235], v[48:51], v[140:143]
    v_mfma_f32_16x16x32_bf16 v[144:147], v[232:235], v[56:59], v[144:147]
    v_xor_b32 v254, 128, v7
    v_xor_b32 v255, 0, v7
    ds_read_b64_tr_b16 v[216:217], v254 offset:57344
    ds_read_b64_tr_b16 v[218:219], v255 offset:58368
    s_waitcnt lgkmcnt(10)
    v_mfma_f32_16x16x32_bf16 v[148:151], v[236:239], v[40:43], v[148:151]
    v_mfma_f32_16x16x32_bf16 v[152:155], v[236:239], v[48:51], v[152:155]
    v_mfma_f32_16x16x32_bf16 v[156:159], v[236:239], v[56:59], v[156:159]
    v_xor_b32 v254, 160, v7
    v_xor_b32 v255, 32, v7
    ds_read_b64_tr_b16 v[220:221], v254 offset:57344
    ds_read_b64_tr_b16 v[222:223], v255 offset:58368
    s_waitcnt lgkmcnt(10)
    v_mfma_f32_16x16x32_bf16 v[64:67], v[240:243], v[44:47], v[64:67]
    v_mfma_f32_16x16x32_bf16 v[68:71], v[240:243], v[52:55], v[68:71]
    v_mfma_f32_16x16x32_bf16 v[72:75], v[240:243], v[60:63], v[72:75]
    v_xor_b32 v254, 192, v7
    v_xor_b32 v255, 64, v7
    ds_read_b64_tr_b16 v[224:225], v254 offset:57344
    ds_read_b64_tr_b16 v[226:227], v255 offset:58368
    s_waitcnt lgkmcnt(10)
    v_mfma_f32_16x16x32_bf16 v[76:79], v[244:247], v[44:47], v[76:79]
    v_mfma_f32_16x16x32_bf16 v[80:83], v[244:247], v[52:55], v[80:83]
    v_mfma_f32_16x16x32_bf16 v[84:87], v[244:247], v[60:63], v[84:87]
    v_xor_b32 v254, 224, v7
    v_xor_b32 v255, 96, v7
    ds_read_b64_tr_b16 v[228:229], v254 offset:57344
    ds_read_b64_tr_b16 v[230:231], v255 offset:58368
    s_waitcnt lgkmcnt(10)
    v_mfma_f32_16x16x32_bf16 v[88:91], v[208:211], v[44:47], v[88:91]
    v_mfma_f32_16x16x32_bf16 v[92:95], v[208:211], v[52:55], v[92:95]
    v_mfma_f32_16x16x32_bf16 v[96:99], v[208:211], v[60:63], v[96:99]
    s_waitcnt lgkmcnt(8)
    v_mfma_f32_16x16x32_bf16 v[100:103], v[212:215], v[44:47], v[100:103]
    v_mfma_f32_16x16x32_bf16 v[104:107], v[212:215], v[52:55], v[104:107]
    v_mfma_f32_16x16x32_bf16 v[108:111], v[212:215], v[60:63], v[108:111]
    s_waitcnt lgkmcnt(6)
    v_mfma_f32_16x16x32_bf16 v[112:115], v[216:219], v[44:47], v[112:115]
    v_mfma_f32_16x16x32_bf16 v[116:119], v[216:219], v[52:55], v[116:119]
    v_mfma_f32_16x16x32_bf16 v[120:123], v[216:219], v[60:63], v[120:123]
    s_waitcnt lgkmcnt(4)
    v_mfma_f32_16x16x32_bf16 v[124:127], v[220:223], v[44:47], v[124:127]
    v_mfma_f32_16x16x32_bf16 v[128:131], v[220:223], v[52:55], v[128:131]
    v_mfma_f32_16x16x32_bf16 v[132:135], v[220:223], v[60:63], v[132:135]
    s_waitcnt lgkmcnt(2)
    v_mfma_f32_16x16x32_bf16 v[136:139], v[224:227], v[44:47], v[136:139]
    v_mfma_f32_16x16x32_bf16 v[140:143], v[224:227], v[52:55], v[140:143]
    v_mfma_f32_16x16x32_bf16 v[144:147], v[224:227], v[60:63], v[144:147]
    s_waitcnt lgkmcnt(0)
    v_mfma_f32_16x16x32_bf16 v[148:151], v[228:231], v[44:47], v[148:151]
    v_mfma_f32_16x16x32_bf16 v[152:155], v[228:231], v[52:55], v[152:155]
    v_mfma_f32_16x16x32_bf16 v[156:159], v[228:231], v[60:63], v[156:159]
    s_nop 9
    v_cvt_pk_bf16_f32 v254, v64, v65
    v_cvt_pk_bf16_f32 v255, v66, v67
    ds_write_b64 v12, v[254:255] offset:0
    v_cvt_pk_bf16_f32 v254, v76, v77
    v_cvt_pk_bf16_f32 v255, v78, v79
    ds_write_b64 v12, v[254:255] offset:32
    v_cvt_pk_bf16_f32 v254, v88, v89
    v_cvt_pk_bf16_f32 v255, v90, v91
    ds_write_b64 v12, v[254:255] offset:64
    v_cvt_pk_bf16_f32 v254, v100, v101
    v_cvt_pk_bf16_f32 v255, v102, v103
    ds_write_b64 v12, v[254:255] offset:96
    v_cvt_pk_bf16_f32 v254, v112, v113
    v_cvt_pk_bf16_f32 v255, v114, v115
    ds_write_b64 v12, v[254:255] offset:128
    v_cvt_pk_bf16_f32 v254, v124, v125
    v_cvt_pk_bf16_f32 v255, v126, v127
    ds_write_b64 v12, v[254:255] offset:160
    v_cvt_pk_bf16_f32 v254, v136, v137
    v_cvt_pk_bf16_f32 v255, v138, v139
    ds_write_b64 v12, v[254:255] offset:192
    v_cvt_pk_bf16_f32 v254, v148, v149
    v_cvt_pk_bf16_f32 v255, v150, v151
    ds_write_b64 v12, v[254:255] offset:224
    s_waitcnt lgkmcnt(0)
    ds_read_b128 v[16:19], v13 offset:0
    ds_read_b128 v[20:23], v13 offset:64
    ds_read_b128 v[24:27], v13 offset:128
    ds_read_b128 v[28:31], v13 offset:192
    s_waitcnt lgkmcnt(0)
    v_cvt_pk_bf16_f32 v254, v68, v69
    v_cvt_pk_bf16_f32 v255, v70, v71
    ds_write_b64 v12, v[254:255] offset:0
    v_cvt_pk_bf16_f32 v254, v80, v81
    v_cvt_pk_bf16_f32 v255, v82, v83
    ds_write_b64 v12, v[254:255] offset:32
    v_cvt_pk_bf16_f32 v254, v92, v93
    v_cvt_pk_bf16_f32 v255, v94, v95
    ds_write_b64 v12, v[254:255] offset:64
    v_cvt_pk_bf16_f32 v254, v104, v105
    v_cvt_pk_bf16_f32 v255, v106, v107
    ds_write_b64 v12, v[254:255] offset:96
    v_cvt_pk_bf16_f32 v254, v116, v117
    v_cvt_pk_bf16_f32 v255, v118, v119
    ds_write_b64 v12, v[254:255] offset:128
    v_cvt_pk_bf16_f32 v254, v128, v129
    v_cvt_pk_bf16_f32 v255, v130, v131
    ds_write_b64 v12, v[254:255] offset:160
    v_cvt_pk_bf16_f32 v254, v140, v141
    v_cvt_pk_bf16_f32 v255, v142, v143
    ds_write_b64 v12, v[254:255] offset:192
    v_cvt_pk_bf16_f32 v254, v152, v153
    v_cvt_pk_bf16_f32 v255, v154, v155
    ds_write_b64 v12, v[254:255] offset:224
    s_waitcnt lgkmcnt(0)
    ds_read_b128 v[32:35], v13 offset:0
    ds_read_b128 v[36:39], v13 offset:64
    ds_read_b128 v[40:43], v13 offset:128
    ds_read_b128 v[44:47], v13 offset:192
    s_waitcnt lgkmcnt(0)
    v_cvt_pk_bf16_f32 v254, v72, v73
    v_cvt_pk_bf16_f32 v255, v74, v75
    ds_write_b64 v12, v[254:255] offset:0
    v_cvt_pk_bf16_f32 v254, v84, v85
    v_cvt_pk_bf16_f32 v255, v86, v87
    ds_write_b64 v12, v[254:255] offset:32
    v_cvt_pk_bf16_f32 v254, v96, v97
    v_cvt_pk_bf16_f32 v255, v98, v99
    ds_write_b64 v12, v[254:255] offset:64
    v_cvt_pk_bf16_f32 v254, v108, v109
    v_cvt_pk_bf16_f32 v255, v110, v111
    ds_write_b64 v12, v[254:255] offset:96
    v_cvt_pk_bf16_f32 v254, v120, v121
    v_cvt_pk_bf16_f32 v255, v122, v123
    ds_write_b64 v12, v[254:255] offset:128
    v_cvt_pk_bf16_f32 v254, v132, v133
    v_cvt_pk_bf16_f32 v255, v134, v135
    ds_write_b64 v12, v[254:255] offset:160
    v_cvt_pk_bf16_f32 v254, v144, v145
    v_cvt_pk_bf16_f32 v255, v146, v147
    ds_write_b64 v12, v[254:255] offset:192
    v_cvt_pk_bf16_f32 v254, v156, v157
    v_cvt_pk_bf16_f32 v255, v158, v159
    ds_write_b64 v12, v[254:255] offset:224
    s_waitcnt lgkmcnt(0)
    ds_read_b128 v[48:51], v13 offset:0
    ds_read_b128 v[52:55], v13 offset:64
    ds_read_b128 v[56:59], v13 offset:128
    ds_read_b128 v[60:63], v13 offset:192
    s_waitcnt lgkmcnt(0)
    v_mov_b32 v64, 0
    v_mov_b32 v65, 0
    v_mov_b32 v66, 0
    v_mov_b32 v67, 0
    v_mov_b32 v68, 0
    v_mov_b32 v69, 0
    v_mov_b32 v70, 0
    v_mov_b32 v71, 0
    v_mov_b32 v72, 0
    v_mov_b32 v73, 0
    v_mov_b32 v74, 0
    v_mov_b32 v75, 0
    v_mov_b32 v76, 0
    v_mov_b32 v77, 0
    v_mov_b32 v78, 0
    v_mov_b32 v79, 0
    v_mov_b32 v80, 0
    v_mov_b32 v81, 0
    v_mov_b32 v82, 0
    v_mov_b32 v83, 0
    v_mov_b32 v84, 0
    v_mov_b32 v85, 0
    v_mov_b32 v86, 0
    v_mov_b32 v87, 0
    v_mov_b32 v88, 0
    v_mov_b32 v89, 0
    v_mov_b32 v90, 0
    v_mov_b32 v91, 0
    v_mov_b32 v92, 0
    v_mov_b32 v93, 0
    v_mov_b32 v94, 0
    v_mov_b32 v95, 0
    v_mov_b32 v96, 0
    v_mov_b32 v97, 0
    v_mov_b32 v98, 0
    v_mov_b32 v99, 0
    v_mov_b32 v100, 0
    v_mov_b32 v101, 0
    v_mov_b32 v102, 0
    v_mov_b32 v103, 0
    v_mov_b32 v104, 0
    v_mov_b32 v105, 0
    v_mov_b32 v106, 0
    v_mov_b32 v107, 0
    v_mov_b32 v108, 0
    v_mov_b32 v109, 0
    v_mov_b32 v110, 0
    v_mov_b32 v111, 0
    v_mov_b32 v112, 0
    v_mov_b32 v113, 0
    v_mov_b32 v114, 0
    v_mov_b32 v115, 0
    v_mov_b32 v116, 0
    v_mov_b32 v117, 0
    v_mov_b32 v118, 0
    v_mov_b32 v119, 0
    v_mov_b32 v120, 0
    v_mov_b32 v121, 0
    v_mov_b32 v122, 0
    v_mov_b32 v123, 0
    v_mov_b32 v124, 0
    v_mov_b32 v125, 0
    v_mov_b32 v126, 0
    v_mov_b32 v127, 0
    v_mov_b32 v128, 0
    v_mov_b32 v129, 0
    v_mov_b32 v130, 0
    v_mov_b32 v131, 0
    v_mov_b32 v132, 0
    v_mov_b32 v133, 0
    v_mov_b32 v134, 0
    v_mov_b32 v135, 0
    v_mov_b32 v136, 0
    v_mov_b32 v137, 0
    v_mov_b32 v138, 0
    v_mov_b32 v139, 0
    v_mov_b32 v140, 0
    v_mov_b32 v141, 0
    v_mov_b32 v142, 0
    v_mov_b32 v143, 0
    v_mov_b32 v144, 0
    v_mov_b32 v145, 0
    v_mov_b32 v146, 0
    v_mov_b32 v147, 0
    v_mov_b32 v148, 0
    v_mov_b32 v149, 0
    v_mov_b32 v150, 0
    v_mov_b32 v151, 0
    v_mov_b32 v152, 0
    v_mov_b32 v153, 0
    v_mov_b32 v154, 0
    v_mov_b32 v155, 0
    v_mov_b32 v156, 0
    v_mov_b32 v157, 0
    v_mov_b32 v158, 0
    v_mov_b32 v159, 0
    v_mov_b32 v248, 0xf149f2ca
    v_mov_b32 v251, 0
    v_mov_b32 v249, 0xf149f2ca
    v_mov_b32 v252, 0
    v_mov_b32 v250, 0xf149f2ca
    v_mov_b32 v253, 0
    s_mov_b32 s44, 0
    s_mov_b32 s45, 0
    s_mov_b32 s46, 0x3e0293ee
attn_loop:
    s_waitcnt vmcnt(0)
    s_barrier
    s_cmp_ge_u32 s44, 7
    s_cbranch_scc1 attn_noload
    s_xor_b32 s42, s45, 0x8000
    s_add_u32 s43, s44, 1
    s_lshl_b32 s43, s43, 14
    s_add_u32 s40, s36, 0
    s_add_u32 m0, s40, s42
    s_add_u32 s40, s40, s43
    buffer_load_dwordx4 v4, s[16:19], s40 offen lds
    s_add_u32 s40, s36, 3072
    s_add_u32 m0, s40, s42
    s_add_u32 s40, s40, s43
    buffer_load_dwordx4 v14, s[16:19], s40 offen lds
    s_add_u32 s40, s36, 6144
    s_add_u32 m0, s40, s42
    s_add_u32 s40, s40, s43
    buffer_load_dwordx4 v4, s[16:19], s40 offen lds
    s_add_u32 s40, s36, 9216
    s_add_u32 m0, s40, s42
    s_add_u32 s40, s40, s43
    buffer_load_dwordx4 v14, s[16:19], s40 offen lds
    s_add_u32 s40, s36, 12288
    s_add_u32 m0, s40, s42
    s_add_u32 s40, s40, s43
    buffer_load_dwordx4 v4, s[16:19], s40 offen lds
    s_cmp_lg_u32 s3, 0
    s_cbranch_scc1 kskip_loop
    s_add_u32 s40, s36, 15360
    s_add_u32 m0, s40, s42
    s_add_u32 s40, s40, s43
    buffer_load_dwordx4 v14, s[16:19], s40 offen lds
kskip_loop:
    s_add_u32 s40, s37, 0
    s_add_u32 m0, s40, s42
    s_add_u32 m0, m0, 0x4000
    s_add_u32 s40, s40, s43
    buffer_load_dwordx4 v4, s[20:23], s40 offen lds
    s_add_u32 s40, s37, 3072
    s_add_u32 m0, s40, s42
    s_add_u32 m0, m0, 0x4000
    s_add_u32 s40, s40, s43
    buffer_load_dwordx4 v14, s[20:23], s40 offen lds
    s_add_u32 s40, s37, 6144
    s_add_u32 m0, s40, s42
    s_add_u32 m0, m0, 0x4000
    s_add_u32 s40, s40, s43
    buffer_load_dwordx4 v4, s[20:23], s40 offen lds
    s_add_u32 s40, s37, 9216
    s_add_u32 m0, s40, s42
    s_add_u32 m0, m0, 0x4000
    s_add_u32 s40, s40, s43
    buffer_load_dwordx4 v14, s[20:23], s40 offen lds
    s_add_u32 s40, s37, 12288
    s_add_u32 m0, s40, s42
    s_add_u32 m0, m0, 0x4000
    s_add_u32 s40, s40, s43
    buffer_load_dwordx4 v4, s[20:23], s40 offen lds
    s_cmp_lg_u32 s3, 2
    s_cbranch_scc1 vskip_loop
    s_add_u32 s40, s37, 15360
    s_add_u32 m0, s40, s42
    s_add_u32 m0, m0, 0x4000
    s_add_u32 s40, s40, s43
    buffer_load_dwordx4 v14, s[20:23], s40 offen lds
vskip_loop:
attn_noload:
    v_xor_b32 v254, 0, v6
    ds_read_b128 v[208:211], v254 offset:0
    v_xor_b32 v254, 64, v6
    ds_read_b128 v[212:215], v254 offset:0
    v_xor_b32 v254, 128, v6
    ds_read_b128 v[216:219], v254 offset:0
    v_xor_b32 v254, 192, v6
    ds_read_b128 v[220:223], v254 offset:0
    v_xor_b32 v254, 0, v6
    ds_read_b128 v[224:227], v254 offset:4096
    v_xor_b32 v254, 64, v6
    ds_read_b128 v[228:231], v254 offset:4096
    s_waitcnt lgkmcnt(5)
    v_mfma_f32_16x16x32_bf16 v[160:163], v[208:211], v[16:19], 0
    v_mfma_f32_16x16x32_bf16 v[164:167], v[208:211], v[32:35], 0
    v_mfma_f32_16x16x32_bf16 v[168:171], v[208:211], v[48:51], 0
    v_xor_b32 v254, 128, v6
    ds_read_b128 v[232:235], v254 offset:4096
    s_waitcnt lgkmcnt(5)
    v_mfma_f32_16x16x32_bf16 v[160:163], v[212:215], v[20:23], v[160:163]
    v_mfma_f32_16x16x32_bf16 v[164:167], v[212:215], v[36:39], v[164:167]
    v_mfma_f32_16x16x32_bf16 v[168:171], v[212:215], v[52:55], v[168:171]
    v_xor_b32 v254, 192, v6
    ds_read_b128 v[236:239], v254 offset:4096
    s_waitcnt lgkmcnt(5)
    v_mfma_f32_16x16x32_bf16 v[160:163], v[216:219], v[24:27], v[160:163]
    v_mfma_f32_16x16x32_bf16 v[164:167], v[216:219], v[40:43], v[164:167]
    v_mfma_f32_16x16x32_bf16 v[168:171], v[216:219], v[56:59], v[168:171]
    v_xor_b32 v254, 0, v6
    ds_read_b128 v[240:243], v254 offset:8192
    s_waitcnt lgkmcnt(5)
    v_mfma_f32_16x16x32_bf16 v[160:163], v[220:223], v[28:31], v[160:163]
    v_mfma_f32_16x16x32_bf16 v[164:167], v[220:223], v[44:47], v[164:167]
    v_mfma_f32_16x16x32_bf16 v[168:171], v[220:223], v[60:63], v[168:171]
    v_xor_b32 v254, 64, v6
    ds_read_b128 v[244:247], v254 offset:8192
    s_waitcnt lgkmcnt(5)
    v_mfma_f32_16x16x32_bf16 v[172:175], v[224:227], v[16:19], 0
    v_mfma_f32_16x16x32_bf16 v[176:179], v[224:227], v[32:35], 0
    v_mfma_f32_16x16x32_bf16 v[180:183], v[224:227], v[48:51], 0
    v_xor_b32 v254, 128, v6
    ds_read_b128 v[208:211], v254 offset:8192
    s_waitcnt lgkmcnt(5)
    v_mfma_f32_16x16x32_bf16 v[172:175], v[228:231], v[20:23], v[172:175]
    v_mfma_f32_16x16x32_bf16 v[176:179], v[228:231], v[36:39], v[176:179]
    v_mfma_f32_16x16x32_bf16 v[180:183], v[228:231], v[52:55], v[180:183]
    v_xor_b32 v254, 192, v6
    ds_read_b128 v[212:215], v254 offset:8192
    s_waitcnt lgkmcnt(5)
    v_mfma_f32_16x16x32_bf16 v[172:175], v[232:235], v[24:27], v[172:175]
    v_mfma_f32_16x16x32_bf16 v[176:179], v[232:235], v[40:43], v[176:179]
    v_mfma_f32_16x16x32_bf16 v[180:183], v[232:235], v[56:59], v[180:183]
    v_xor_b32 v254, 0, v6
    ds_read_b128 v[216:219], v254 offset:12288
    s_waitcnt lgkmcnt(5)
    v_mfma_f32_16x16x32_bf16 v[172:175], v[236:239], v[28:31], v[172:175]
    v_mfma_f32_16x16x32_bf16 v[176:179], v[236:239], v[44:47], v[176:179]
    v_mfma_f32_16x16x32_bf16 v[180:183], v[236:239], v[60:63], v[180:183]
    v_xor_b32 v254, 64, v6
    ds_read_b128 v[220:223], v254 offset:12288
    s_waitcnt lgkmcnt(5)
    v_mfma_f32_16x16x32_bf16 v[184:187], v[240:243], v[16:19], 0
    v_mfma_f32_16x16x32_bf16 v[188:191], v[240:243], v[32:35], 0
    v_mfma_f32_16x16x32_bf16 v[192:195], v[240:243], v[48:51], 0
    v_xor_b32 v254, 128, v6
    ds_read_b128 v[224:227], v254 offset:12288
    s_waitcnt lgkmcnt(5)
    v_mfma_f32_16x16x32_bf16 v[184:187], v[244:247], v[20:23], v[184:187]
    v_mfma_f32_16x16x32_bf16 v[188:191], v[244:247], v[36:39], v[188:191]
    v_mfma_f32_16x16x32_bf16 v[192:195], v[244:247], v[52:55], v[192:195]
    v_xor_b32 v254, 192, v6
    ds_read_b128 v[228:231], v254 offset:12288
    s_waitcnt lgkmcnt(5)
    v_mfma_f32_16x16x32_bf16 v[184:187], v[208:211], v[24:27], v[184:187]
    v_mfma_f32_16x16x32_bf16 v[188:191], v[208:211], v[40:43], v[188:191]
    v_mfma_f32_16x16x32_bf16 v[192:195], v[208:211], v[56:59], v[192:195]
    s_waitcnt lgkmcnt(4)
    v_mfma_f32_16x16x32_bf16 v[184:187], v[212:215], v[28:31], v[184:187]
    v_mfma_f32_16x16x32_bf16 v[188:191], v[212:215], v[44:47], v[188:191]
    v_mfma_f32_16x16x32_bf16 v[192:195], v[212:215], v[60:63], v[192:195]
    s_waitcnt lgkmcnt(3)
    v_mfma_f32_16x16x32_bf16 v[196:199], v[216:219], v[16:19], 0
    v_mfma_f32_16x16x32_bf16 v[200:203], v[216:219], v[32:35], 0
    v_mfma_f32_16x16x32_bf16 v[204:207], v[216:219], v[48:51], 0
    s_waitcnt lgkmcnt(2)
    v_mfma_f32_16x16x32_bf16 v[196:199], v[220:223], v[20:23], v[196:199]
    v_mfma_f32_16x16x32_bf16 v[200:203], v[220:223], v[36:39], v[200:203]
    v_mfma_f32_16x16x32_bf16 v[204:207], v[220:223], v[52:55], v[204:207]
    s_waitcnt lgkmcnt(1)
    v_mfma_f32_16x16x32_bf16 v[196:199], v[224:227], v[24:27], v[196:199]
    v_mfma_f32_16x16x32_bf16 v[200:203], v[224:227], v[40:43], v[200:203]
    v_mfma_f32_16x16x32_bf16 v[204:207], v[224:227], v[56:59], v[204:207]
    s_waitcnt lgkmcnt(0)
    v_mfma_f32_16x16x32_bf16 v[196:199], v[228:231], v[28:31], v[196:199]
    v_mfma_f32_16x16x32_bf16 v[200:203], v[228:231], v[44:47], v[200:203]
    v_mfma_f32_16x16x32_bf16 v[204:207], v[228:231], v[60:63], v[204:207]
    s_nop 9
    v_max3_f32 v254, v160, v161, v162
    v_max3_f32 v254, v254, v163, v172
    v_max3_f32 v254, v254, v173, v174
    v_max3_f32 v254, v254, v175, v184
    v_max3_f32 v254, v254, v185, v186
    v_max3_f32 v254, v254, v187, v196
    v_max3_f32 v254, v254, v197, v198
    v_max_f32 v254, v254, v199
    v_mov_b32 v255, v254
    s_nop 1
    v_permlane16_swap_b32 v254, v255
    s_nop 1
    v_max_f32 v254, v254, v255
    v_mov_b32 v255, v254
    s_nop 1
    v_permlane32_swap_b32 v254, v255
    s_nop 1
    v_max_f32 v254, v254, v255
    v_max_f32 v254, v254, v248
    v_sub_f32 v255, v248, v254
    v_mul_f32 v255, s46, v255
    v_exp_f32 v255, v255
    v_mov_b32 v248, v254
    v_mul_f32 v254, s46, v254
    v_sub_f32 v254, 0, v254
    v_fma_f32 v160, v160, s46, v254
    v_fma_f32 v161, v161, s46, v254
    v_fma_f32 v162, v162, s46, v254
    v_fma_f32 v163, v163, s46, v254
    v_fma_f32 v172, v172, s46, v254
    v_fma_f32 v173, v173, s46, v254
    v_fma_f32 v174, v174, s46, v254
    v_fma_f32 v175, v175, s46, v254
    v_fma_f32 v184, v184, s46, v254
    v_fma_f32 v185, v185, s46, v254
    v_fma_f32 v186, v186, s46, v254
    v_fma_f32 v187, v187, s46, v254
    v_fma_f32 v196, v196, s46, v254
    v_fma_f32 v197, v197, s46, v254
    v_fma_f32 v198, v198, s46, v254
    v_fma_f32 v199, v199, s46, v254
    v_exp_f32 v160, v160
    v_exp_f32 v161, v161
    v_exp_f32 v162, v162
    v_exp_f32 v163, v163
    v_exp_f32 v172, v172
    v_exp_f32 v173, v173
    v_exp_f32 v174, v174
    v_exp_f32 v175, v175
    v_exp_f32 v184, v184
    v_exp_f32 v185, v185
    v_exp_f32 v186, v186
    v_exp_f32 v187, v187
    v_exp_f32 v196, v196
    v_exp_f32 v197, v197
    v_exp_f32 v198, v198
    v_exp_f32 v199, v199
    v_mul_f32 v251, v251, v255
    v_add_f32 v251, v251, v160
    v_add_f32 v251, v251, v161
    v_add_f32 v251, v251, v162
    v_add_f32 v251, v251, v163
    v_add_f32 v251, v251, v172
    v_add_f32 v251, v251, v173
    v_add_f32 v251, v251, v174
    v_add_f32 v251, v251, v175
    v_add_f32 v251, v251, v184
    v_add_f32 v251, v251, v185
    v_add_f32 v251, v251, v186
    v_add_f32 v251, v251, v187
    v_add_f32 v251, v251, v196
    v_add_f32 v251, v251, v197
    v_add_f32 v251, v251, v198
    v_add_f32 v251, v251, v199
    v_mul_f32 v64, v64, v255
    v_mul_f32 v65, v65, v255
    v_mul_f32 v66, v66, v255
    v_mul_f32 v67, v67, v255
    v_mul_f32 v76, v76, v255
    v_mul_f32 v77, v77, v255
    v_mul_f32 v78, v78, v255
    v_mul_f32 v79, v79, v255
    v_mul_f32 v88, v88, v255
    v_mul_f32 v89, v89, v255
    v_mul_f32 v90, v90, v255
    v_mul_f32 v91, v91, v255
    v_mul_f32 v100, v100, v255
    v_mul_f32 v101, v101, v255
    v_mul_f32 v102, v102, v255
    v_mul_f32 v103, v103, v255
    v_mul_f32 v112, v112, v255
    v_mul_f32 v113, v113, v255
    v_mul_f32 v114, v114, v255
    v_mul_f32 v115, v115, v255
    v_mul_f32 v124, v124, v255
    v_mul_f32 v125, v125, v255
    v_mul_f32 v126, v126, v255
    v_mul_f32 v127, v127, v255
    v_mul_f32 v136, v136, v255
    v_mul_f32 v137, v137, v255
    v_mul_f32 v138, v138, v255
    v_mul_f32 v139, v139, v255
    v_mul_f32 v148, v148, v255
    v_mul_f32 v149, v149, v255
    v_mul_f32 v150, v150, v255
    v_mul_f32 v151, v151, v255
    v_cvt_pk_bf16_f32 v208, v160, v161
    v_cvt_pk_bf16_f32 v209, v162, v163
    v_cvt_pk_bf16_f32 v210, v172, v173
    v_cvt_pk_bf16_f32 v211, v174, v175
    v_cvt_pk_bf16_f32 v220, v184, v185
    v_cvt_pk_bf16_f32 v221, v186, v187
    v_cvt_pk_bf16_f32 v222, v196, v197
    v_cvt_pk_bf16_f32 v223, v198, v199
    v_max3_f32 v254, v164, v165, v166
    v_max3_f32 v254, v254, v167, v176
    v_max3_f32 v254, v254, v177, v178
    v_max3_f32 v254, v254, v179, v188
    v_max3_f32 v254, v254, v189, v190
    v_max3_f32 v254, v254, v191, v200
    v_max3_f32 v254, v254, v201, v202
    v_max_f32 v254, v254, v203
    v_mov_b32 v255, v254
    s_nop 1
    v_permlane16_swap_b32 v254, v255
    s_nop 1
    v_max_f32 v254, v254, v255
    v_mov_b32 v255, v254
    s_nop 1
    v_permlane32_swap_b32 v254, v255
    s_nop 1
    v_max_f32 v254, v254, v255
    v_max_f32 v254, v254, v249
    v_sub_f32 v255, v249, v254
    v_mul_f32 v255, s46, v255
    v_exp_f32 v255, v255
    v_mov_b32 v249, v254
    v_mul_f32 v254, s46, v254
    v_sub_f32 v254, 0, v254
    v_fma_f32 v164, v164, s46, v254
    v_fma_f32 v165, v165, s46, v254
    v_fma_f32 v166, v166, s46, v254
    v_fma_f32 v167, v167, s46, v254
    v_fma_f32 v176, v176, s46, v254
    v_fma_f32 v177, v177, s46, v254
    v_fma_f32 v178, v178, s46, v254
    v_fma_f32 v179, v179, s46, v254
    v_fma_f32 v188, v188, s46, v254
    v_fma_f32 v189, v189, s46, v254
    v_fma_f32 v190, v190, s46, v254
    v_fma_f32 v191, v191, s46, v254
    v_fma_f32 v200, v200, s46, v254
    v_fma_f32 v201, v201, s46, v254
    v_fma_f32 v202, v202, s46, v254
    v_fma_f32 v203, v203, s46, v254
    v_exp_f32 v164, v164
    v_exp_f32 v165, v165
    v_exp_f32 v166, v166
    v_exp_f32 v167, v167
    v_exp_f32 v176, v176
    v_exp_f32 v177, v177
    v_exp_f32 v178, v178
    v_exp_f32 v179, v179
    v_exp_f32 v188, v188
    v_exp_f32 v189, v189
    v_exp_f32 v190, v190
    v_exp_f32 v191, v191
    v_exp_f32 v200, v200
    v_exp_f32 v201, v201
    v_exp_f32 v202, v202
    v_exp_f32 v203, v203
    v_mul_f32 v252, v252, v255
    v_add_f32 v252, v252, v164
    v_add_f32 v252, v252, v165
    v_add_f32 v252, v252, v166
    v_add_f32 v252, v252, v167
    v_add_f32 v252, v252, v176
    v_add_f32 v252, v252, v177
    v_add_f32 v252, v252, v178
    v_add_f32 v252, v252, v179
    v_add_f32 v252, v252, v188
    v_add_f32 v252, v252, v189
    v_add_f32 v252, v252, v190
    v_add_f32 v252, v252, v191
    v_add_f32 v252, v252, v200
    v_add_f32 v252, v252, v201
    v_add_f32 v252, v252, v202
    v_add_f32 v252, v252, v203
    v_mul_f32 v68, v68, v255
    v_mul_f32 v69, v69, v255
    v_mul_f32 v70, v70, v255
    v_mul_f32 v71, v71, v255
    v_mul_f32 v80, v80, v255
    v_mul_f32 v81, v81, v255
    v_mul_f32 v82, v82, v255
    v_mul_f32 v83, v83, v255
    v_mul_f32 v92, v92, v255
    v_mul_f32 v93, v93, v255
    v_mul_f32 v94, v94, v255
    v_mul_f32 v95, v95, v255
    v_mul_f32 v104, v104, v255
    v_mul_f32 v105, v105, v255
    v_mul_f32 v106, v106, v255
    v_mul_f32 v107, v107, v255
    v_mul_f32 v116, v116, v255
    v_mul_f32 v117, v117, v255
    v_mul_f32 v118, v118, v255
    v_mul_f32 v119, v119, v255
    v_mul_f32 v128, v128, v255
    v_mul_f32 v129, v129, v255
    v_mul_f32 v130, v130, v255
    v_mul_f32 v131, v131, v255
    v_mul_f32 v140, v140, v255
    v_mul_f32 v141, v141, v255
    v_mul_f32 v142, v142, v255
    v_mul_f32 v143, v143, v255
    v_mul_f32 v152, v152, v255
    v_mul_f32 v153, v153, v255
    v_mul_f32 v154, v154, v255
    v_mul_f32 v155, v155, v255
    v_cvt_pk_bf16_f32 v212, v164, v165
    v_cvt_pk_bf16_f32 v213, v166, v167
    v_cvt_pk_bf16_f32 v214, v176, v177
    v_cvt_pk_bf16_f32 v215, v178, v179
    v_cvt_pk_bf16_f32 v224, v188, v189
    v_cvt_pk_bf16_f32 v225, v190, v191
    v_cvt_pk_bf16_f32 v226, v200, v201
    v_cvt_pk_bf16_f32 v227, v202, v203
    v_max3_f32 v254, v168, v169, v170
    v_max3_f32 v254, v254, v171, v180
    v_max3_f32 v254, v254, v181, v182
    v_max3_f32 v254, v254, v183, v192
    v_max3_f32 v254, v254, v193, v194
    v_max3_f32 v254, v254, v195, v204
    v_max3_f32 v254, v254, v205, v206
    v_max_f32 v254, v254, v207
    v_mov_b32 v255, v254
    s_nop 1
    v_permlane16_swap_b32 v254, v255
    s_nop 1
    v_max_f32 v254, v254, v255
    v_mov_b32 v255, v254
    s_nop 1
    v_permlane32_swap_b32 v254, v255
    s_nop 1
    v_max_f32 v254, v254, v255
    v_max_f32 v254, v254, v250
    v_sub_f32 v255, v250, v254
    v_mul_f32 v255, s46, v255
    v_exp_f32 v255, v255
    v_mov_b32 v250, v254
    v_mul_f32 v254, s46, v254
    v_sub_f32 v254, 0, v254
    v_fma_f32 v168, v168, s46, v254
    v_fma_f32 v169, v169, s46, v254
    v_fma_f32 v170, v170, s46, v254
    v_fma_f32 v171, v171, s46, v254
    v_fma_f32 v180, v180, s46, v254
    v_fma_f32 v181, v181, s46, v254
    v_fma_f32 v182, v182, s46, v254
    v_fma_f32 v183, v183, s46, v254
    v_fma_f32 v192, v192, s46, v254
    v_fma_f32 v193, v193, s46, v254
    v_fma_f32 v194, v194, s46, v254
    v_fma_f32 v195, v195, s46, v254
    v_fma_f32 v204, v204, s46, v254
    v_fma_f32 v205, v205, s46, v254
    v_fma_f32 v206, v206, s46, v254
    v_fma_f32 v207, v207, s46, v254
    v_exp_f32 v168, v168
    v_exp_f32 v169, v169
    v_exp_f32 v170, v170
    v_exp_f32 v171, v171
    v_exp_f32 v180, v180
    v_exp_f32 v181, v181
    v_exp_f32 v182, v182
    v_exp_f32 v183, v183
    v_exp_f32 v192, v192
    v_exp_f32 v193, v193
    v_exp_f32 v194, v194
    v_exp_f32 v195, v195
    v_exp_f32 v204, v204
    v_exp_f32 v205, v205
    v_exp_f32 v206, v206
    v_exp_f32 v207, v207
    v_mul_f32 v253, v253, v255
    v_add_f32 v253, v253, v168
    v_add_f32 v253, v253, v169
    v_add_f32 v253, v253, v170
    v_add_f32 v253, v253, v171
    v_add_f32 v253, v253, v180
    v_add_f32 v253, v253, v181
    v_add_f32 v253, v253, v182
    v_add_f32 v253, v253, v183
    v_add_f32 v253, v253, v192
    v_add_f32 v253, v253, v193
    v_add_f32 v253, v253, v194
    v_add_f32 v253, v253, v195
    v_add_f32 v253, v253, v204
    v_add_f32 v253, v253, v205
    v_add_f32 v253, v253, v206
    v_add_f32 v253, v253, v207
    v_mul_f32 v72, v72, v255
    v_mul_f32 v73, v73, v255
    v_mul_f32 v74, v74, v255
    v_mul_f32 v75, v75, v255
    v_mul_f32 v84, v84, v255
    v_mul_f32 v85, v85, v255
    v_mul_f32 v86, v86, v255
    v_mul_f32 v87, v87, v255
    v_mul_f32 v96, v96, v255
    v_mul_f32 v97, v97, v255
    v_mul_f32 v98, v98, v255
    v_mul_f32 v99, v99, v255
    v_mul_f32 v108, v108, v255
    v_mul_f32 v109, v109, v255
    v_mul_f32 v110, v110, v255
    v_mul_f32 v111, v111, v255
    v_mul_f32 v120, v120, v255
    v_mul_f32 v121, v121, v255
    v_mul_f32 v122, v122, v255
    v_mul_f32 v123, v123, v255
    v_mul_f32 v132, v132, v255
    v_mul_f32 v133, v133, v255
    v_mul_f32 v134, v134, v255
    v_mul_f32 v135, v135, v255
    v_mul_f32 v144, v144, v255
    v_mul_f32 v145, v145, v255
    v_mul_f32 v146, v146, v255
    v_mul_f32 v147, v147, v255
    v_mul_f32 v156, v156, v255
    v_mul_f32 v157, v157, v255
    v_mul_f32 v158, v158, v255
    v_mul_f32 v159, v159, v255
    v_cvt_pk_bf16_f32 v216, v168, v169
    v_cvt_pk_bf16_f32 v217, v170, v171
    v_cvt_pk_bf16_f32 v218, v180, v181
    v_cvt_pk_bf16_f32 v219, v182, v183
    v_cvt_pk_bf16_f32 v228, v192, v193
    v_cvt_pk_bf16_f32 v229, v194, v195
    v_cvt_pk_bf16_f32 v230, v204, v205
    v_cvt_pk_bf16_f32 v231, v206, v207
    s_nop 3
    v_xor_b32 v254, 0, v8
    ds_read_b64_tr_b16 v[160:161], v254 offset:0
    ds_read_b64_tr_b16 v[162:163], v254 offset:4096
    v_xor_b32 v254, 32, v8
    ds_read_b64_tr_b16 v[164:165], v254 offset:0
    ds_read_b64_tr_b16 v[166:167], v254 offset:4096
    v_xor_b32 v254, 64, v8
    ds_read_b64_tr_b16 v[168:169], v254 offset:0
    ds_read_b64_tr_b16 v[170:171], v254 offset:4096
    v_xor_b32 v254, 96, v8
    ds_read_b64_tr_b16 v[172:173], v254 offset:0
    ds_read_b64_tr_b16 v[174:175], v254 offset:4096
    v_xor_b32 v254, 128, v8
    ds_read_b64_tr_b16 v[176:177], v254 offset:0
    ds_read_b64_tr_b16 v[178:179], v254 offset:4096
    v_xor_b32 v254, 160, v8
    ds_read_b64_tr_b16 v[180:181], v254 offset:0
    ds_read_b64_tr_b16 v[182:183], v254 offset:4096
    v_xor_b32 v254, 192, v8
    ds_read_b64_tr_b16 v[184:185], v254 offset:0
    ds_read_b64_tr_b16 v[186:187], v254 offset:4096
    v_xor_b32 v254, 224, v8
    ds_read_b64_tr_b16 v[188:189], v254 offset:0
    ds_read_b64_tr_b16 v[190:191], v254 offset:4096
    s_waitcnt lgkmcnt(14)
    v_mfma_f32_16x16x32_bf16 v[64:67], v[160:163], v[208:211], v[64:67]
    v_mfma_f32_16x16x32_bf16 v[68:71], v[160:163], v[212:215], v[68:71]
    v_mfma_f32_16x16x32_bf16 v[72:75], v[160:163], v[216:219], v[72:75]
    v_xor_b32 v254, 0, v8
    ds_read_b64_tr_b16 v[192:193], v254 offset:8192
    ds_read_b64_tr_b16 v[194:195], v254 offset:12288
    s_waitcnt lgkmcnt(14)
    v_mfma_f32_16x16x32_bf16 v[76:79], v[164:167], v[208:211], v[76:79]
    v_mfma_f32_16x16x32_bf16 v[80:83], v[164:167], v[212:215], v[80:83]
    v_mfma_f32_16x16x32_bf16 v[84:87], v[164:167], v[216:219], v[84:87]
    v_xor_b32 v254, 32, v8
    ds_read_b64_tr_b16 v[196:197], v254 offset:8192
    ds_read_b64_tr_b16 v[198:199], v254 offset:12288
    s_waitcnt lgkmcnt(14)
    v_mfma_f32_16x16x32_bf16 v[88:91], v[168:171], v[208:211], v[88:91]
    v_mfma_f32_16x16x32_bf16 v[92:95], v[168:171], v[212:215], v[92:95]
    v_mfma_f32_16x16x32_bf16 v[96:99], v[168:171], v[216:219], v[96:99]
    v_xor_b32 v254, 64, v8
    ds_read_b64_tr_b16 v[200:201], v254 offset:8192
    ds_read_b64_tr_b16 v[202:203], v254 offset:12288
    s_waitcnt lgkmcnt(14)
    v_mfma_f32_16x16x32_bf16 v[100:103], v[172:175], v[208:211], v[100:103]
    v_mfma_f32_16x16x32_bf16 v[104:107], v[172:175], v[212:215], v[104:107]
    v_mfma_f32_16x16x32_bf16 v[108:111], v[172:175], v[216:219], v[108:111]
    v_xor_b32 v254, 96, v8
    ds_read_b64_tr_b16 v[204:205], v254 offset:8192
    ds_read_b64_tr_b16 v[206:207], v254 offset:12288
    s_waitcnt lgkmcnt(14)
    v_mfma_f32_16x16x32_bf16 v[112:115], v[176:179], v[208:211], v[112:115]
    v_mfma_f32_16x16x32_bf16 v[116:119], v[176:179], v[212:215], v[116:119]
    v_mfma_f32_16x16x32_bf16 v[120:123], v[176:179], v[216:219], v[120:123]
    v_xor_b32 v254, 128, v8
    ds_read_b64_tr_b16 v[160:161], v254 offset:8192
    ds_read_b64_tr_b16 v[162:163], v254 offset:12288
    s_waitcnt lgkmcnt(14)
    v_mfma_f32_16x16x32_bf16 v[124:127], v[180:183], v[208:211], v[124:127]
    v_mfma_f32_16x16x32_bf16 v[128:131], v[180:183], v[212:215], v[128:131]
    v_mfma_f32_16x16x32_bf16 v[132:135], v[180:183], v[216:219], v[132:135]
    v_xor_b32 v254, 160, v8
    ds_read_b64_tr_b16 v[164:165], v254 offset:8192
    ds_read_b64_tr_b16 v[166:167], v254 offset:12288
    s_waitcnt lgkmcnt(14)
    v_mfma_f32_16x16x32_bf16 v[136:139], v[184:187], v[208:211], v[136:139]
    v_mfma_f32_16x16x32_bf16 v[140:143], v[184:187], v[212:215], v[140:143]
    v_mfma_f32_16x16x32_bf16 v[144:147], v[184:187], v[216:219], v[144:147]
    v_xor_b32 v254, 192, v8
    ds_read_b64_tr_b16 v[168:169], v254 offset:8192
    ds_read_b64_tr_b16 v[170:171], v254 offset:12288
    s_waitcnt lgkmcnt(14)
    v_mfma_f32_16x16x32_bf16 v[148:151], v[188:191], v[208:211], v[148:151]
    v_mfma_f32_16x16x32_bf16 v[152:155], v[188:191], v[212:215], v[152:155]
    v_mfma_f32_16x16x32_bf16 v[156:159], v[188:191], v[216:219], v[156:159]
    v_xor_b32 v254, 224, v8
    ds_read_b64_tr_b16 v[172:173], v254 offset:8192
    ds_read_b64_tr_b16 v[174:175], v254 offset:12288
    s_waitcnt lgkmcnt(14)
    v_mfma_f32_16x16x32_bf16 v[64:67], v[192:195], v[220:223], v[64:67]
    v_mfma_f32_16x16x32_bf16 v[68:71], v[192:195], v[224:227], v[68:71]
    v_mfma_f32_16x16x32_bf16 v[72:75], v[192:195], v[228:231], v[72:75]
    s_waitcnt lgkmcnt(12)
    v_mfma_f32_16x16x32_bf16 v[76:79], v[196:199], v[220:223], v[76:79]
    v_mfma_f32_16x16x32_bf16 v[80:83], v[196:199], v[224:227], v[80:83]
    v_mfma_f32_16x16x32_bf16 v[84:87], v[196:199], v[228:231], v[84:87]
    s_waitcnt lgkmcnt(10)
    v_mfma_f32_16x16x32_bf16 v[88:91], v[200:203], v[220:223], v[88:91]
    v_mfma_f32_16x16x32_bf16 v[92:95], v[200:203], v[224:227], v[92:95]
    v_mfma_f32_16x16x32_bf16 v[96:99], v[200:203], v[228:231], v[96:99]
    s_waitcnt lgkmcnt(8)
    v_mfma_f32_16x16x32_bf16 v[100:103], v[204:207], v[220:223], v[100:103]
    v_mfma_f32_16x16x32_bf16 v[104:107], v[204:207], v[224:227], v[104:107]
    v_mfma_f32_16x16x32_bf16 v[108:111], v[204:207], v[228:231], v[108:111]
    s_waitcnt lgkmcnt(6)
    v_mfma_f32_16x16x32_bf16 v[112:115], v[160:163], v[220:223], v[112:115]
    v_mfma_f32_16x16x32_bf16 v[116:119], v[160:163], v[224:227], v[116:119]
    v_mfma_f32_16x16x32_bf16 v[120:123], v[160:163], v[228:231], v[120:123]
    s_waitcnt lgkmcnt(4)
    v_mfma_f32_16x16x32_bf16 v[124:127], v[164:167], v[220:223], v[124:127]
    v_mfma_f32_16x16x32_bf16 v[128:131], v[164:167], v[224:227], v[128:131]
    v_mfma_f32_16x16x32_bf16 v[132:135], v[164:167], v[228:231], v[132:135]
    s_waitcnt lgkmcnt(2)
    v_mfma_f32_16x16x32_bf16 v[136:139], v[168:171], v[220:223], v[136:139]
    v_mfma_f32_16x16x32_bf16 v[140:143], v[168:171], v[224:227], v[140:143]
    v_mfma_f32_16x16x32_bf16 v[144:147], v[168:171], v[228:231], v[144:147]
    s_waitcnt lgkmcnt(0)
    v_mfma_f32_16x16x32_bf16 v[148:151], v[172:175], v[220:223], v[148:151]
    v_mfma_f32_16x16x32_bf16 v[152:155], v[172:175], v[224:227], v[152:155]
    v_mfma_f32_16x16x32_bf16 v[156:159], v[172:175], v[228:231], v[156:159]
    s_xor_b32 s45, s45, 0x8000
    v_xor_b32 v6, 0x8000, v6
    v_xor_b32 v8, 0x8000, v8
    s_add_u32 s44, s44, 1
    s_cmp_lt_u32 s44, 8
    s_nop 7
    s_cbranch_scc1 attn_loop
    s_nop 7
    v_mov_b32 v254, v251
    v_mov_b32 v255, v254
    s_nop 1
    v_permlane16_swap_b32 v254, v255
    s_nop 1
    v_add_f32 v254, v254, v255
    v_mov_b32 v255, v254
    s_nop 1
    v_permlane32_swap_b32 v254, v255
    s_nop 1
    v_add_f32 v254, v254, v255
    v_rcp_f32 v254, v254
    s_mov_b32 s41, 0
    s_nop 0
    v_mul_f32 v64, v64, v254
    v_mul_f32 v65, v65, v254
    v_mul_f32 v66, v66, v254
    v_mul_f32 v67, v67, v254
    v_cvt_pk_bf16_f32 v64, v64, v65
    v_cvt_pk_bf16_f32 v65, v66, v67
    buffer_store_dwordx2 v[64:65], v11, s[32:35], s41 offen offset:0
    v_mul_f32 v76, v76, v254
    v_mul_f32 v77, v77, v254
    v_mul_f32 v78, v78, v254
    v_mul_f32 v79, v79, v254
    v_cvt_pk_bf16_f32 v76, v76, v77
    v_cvt_pk_bf16_f32 v77, v78, v79
    buffer_store_dwordx2 v[76:77], v11, s[32:35], s41 offen offset:32
    v_mul_f32 v88, v88, v254
    v_mul_f32 v89, v89, v254
    v_mul_f32 v90, v90, v254
    v_mul_f32 v91, v91, v254
    v_cvt_pk_bf16_f32 v88, v88, v89
    v_cvt_pk_bf16_f32 v89, v90, v91
    buffer_store_dwordx2 v[88:89], v11, s[32:35], s41 offen offset:64
    v_mul_f32 v100, v100, v254
    v_mul_f32 v101, v101, v254
    v_mul_f32 v102, v102, v254
    v_mul_f32 v103, v103, v254
    v_cvt_pk_bf16_f32 v100, v100, v101
    v_cvt_pk_bf16_f32 v101, v102, v103
    buffer_store_dwordx2 v[100:101], v11, s[32:35], s41 offen offset:96
    v_mul_f32 v112, v112, v254
    v_mul_f32 v113, v113, v254
    v_mul_f32 v114, v114, v254
    v_mul_f32 v115, v115, v254
    v_cvt_pk_bf16_f32 v112, v112, v113
    v_cvt_pk_bf16_f32 v113, v114, v115
    buffer_store_dwordx2 v[112:113], v11, s[32:35], s41 offen offset:128
    v_mul_f32 v124, v124, v254
    v_mul_f32 v125, v125, v254
    v_mul_f32 v126, v126, v254
    v_mul_f32 v127, v127, v254
    v_cvt_pk_bf16_f32 v124, v124, v125
    v_cvt_pk_bf16_f32 v125, v126, v127
    buffer_store_dwordx2 v[124:125], v11, s[32:35], s41 offen offset:160
    v_mul_f32 v136, v136, v254
    v_mul_f32 v137, v137, v254
    v_mul_f32 v138, v138, v254
    v_mul_f32 v139, v139, v254
    v_cvt_pk_bf16_f32 v136, v136, v137
    v_cvt_pk_bf16_f32 v137, v138, v139
    buffer_store_dwordx2 v[136:137], v11, s[32:35], s41 offen offset:192
    v_mul_f32 v148, v148, v254
    v_mul_f32 v149, v149, v254
    v_mul_f32 v150, v150, v254
    v_mul_f32 v151, v151, v254
    v_cvt_pk_bf16_f32 v148, v148, v149
    v_cvt_pk_bf16_f32 v149, v150, v151
    buffer_store_dwordx2 v[148:149], v11, s[32:35], s41 offen offset:224
    v_mov_b32 v254, v252
    v_mov_b32 v255, v254
    s_nop 1
    v_permlane16_swap_b32 v254, v255
    s_nop 1
    v_add_f32 v254, v254, v255
    v_mov_b32 v255, v254
    s_nop 1
    v_permlane32_swap_b32 v254, v255
    s_nop 1
    v_add_f32 v254, v254, v255
    v_rcp_f32 v254, v254
    s_mov_b32 s41, 131072
    s_nop 0
    v_mul_f32 v68, v68, v254
    v_mul_f32 v69, v69, v254
    v_mul_f32 v70, v70, v254
    v_mul_f32 v71, v71, v254
    v_cvt_pk_bf16_f32 v68, v68, v69
    v_cvt_pk_bf16_f32 v69, v70, v71
    buffer_store_dwordx2 v[68:69], v11, s[32:35], s41 offen offset:0
    v_mul_f32 v80, v80, v254
    v_mul_f32 v81, v81, v254
    v_mul_f32 v82, v82, v254
    v_mul_f32 v83, v83, v254
    v_cvt_pk_bf16_f32 v80, v80, v81
    v_cvt_pk_bf16_f32 v81, v82, v83
    buffer_store_dwordx2 v[80:81], v11, s[32:35], s41 offen offset:32
    v_mul_f32 v92, v92, v254
    v_mul_f32 v93, v93, v254
    v_mul_f32 v94, v94, v254
    v_mul_f32 v95, v95, v254
    v_cvt_pk_bf16_f32 v92, v92, v93
    v_cvt_pk_bf16_f32 v93, v94, v95
    buffer_store_dwordx2 v[92:93], v11, s[32:35], s41 offen offset:64
    v_mul_f32 v104, v104, v254
    v_mul_f32 v105, v105, v254
    v_mul_f32 v106, v106, v254
    v_mul_f32 v107, v107, v254
    v_cvt_pk_bf16_f32 v104, v104, v105
    v_cvt_pk_bf16_f32 v105, v106, v107
    buffer_store_dwordx2 v[104:105], v11, s[32:35], s41 offen offset:96
    v_mul_f32 v116, v116, v254
    v_mul_f32 v117, v117, v254
    v_mul_f32 v118, v118, v254
    v_mul_f32 v119, v119, v254
    v_cvt_pk_bf16_f32 v116, v116, v117
    v_cvt_pk_bf16_f32 v117, v118, v119
    buffer_store_dwordx2 v[116:117], v11, s[32:35], s41 offen offset:128
    v_mul_f32 v128, v128, v254
    v_mul_f32 v129, v129, v254
    v_mul_f32 v130, v130, v254
    v_mul_f32 v131, v131, v254
    v_cvt_pk_bf16_f32 v128, v128, v129
    v_cvt_pk_bf16_f32 v129, v130, v131
    buffer_store_dwordx2 v[128:129], v11, s[32:35], s41 offen offset:160
    v_mul_f32 v140, v140, v254
    v_mul_f32 v141, v141, v254
    v_mul_f32 v142, v142, v254
    v_mul_f32 v143, v143, v254
    v_cvt_pk_bf16_f32 v140, v140, v141
    v_cvt_pk_bf16_f32 v141, v142, v143
    buffer_store_dwordx2 v[140:141], v11, s[32:35], s41 offen offset:192
    v_mul_f32 v152, v152, v254
    v_mul_f32 v153, v153, v254
    v_mul_f32 v154, v154, v254
    v_mul_f32 v155, v155, v254
    v_cvt_pk_bf16_f32 v152, v152, v153
    v_cvt_pk_bf16_f32 v153, v154, v155
    buffer_store_dwordx2 v[152:153], v11, s[32:35], s41 offen offset:224
    v_mov_b32 v254, v253
    v_mov_b32 v255, v254
    s_nop 1
    v_permlane16_swap_b32 v254, v255
    s_nop 1
    v_add_f32 v254, v254, v255
    v_mov_b32 v255, v254
    s_nop 1
    v_permlane32_swap_b32 v254, v255
    s_nop 1
    v_add_f32 v254, v254, v255
    v_rcp_f32 v254, v254
    s_mov_b32 s41, 262144
    s_nop 0
    v_mul_f32 v72, v72, v254
    v_mul_f32 v73, v73, v254
    v_mul_f32 v74, v74, v254
    v_mul_f32 v75, v75, v254
    v_cvt_pk_bf16_f32 v72, v72, v73
    v_cvt_pk_bf16_f32 v73, v74, v75
    buffer_store_dwordx2 v[72:73], v11, s[32:35], s41 offen offset:0
    v_mul_f32 v84, v84, v254
    v_mul_f32 v85, v85, v254
    v_mul_f32 v86, v86, v254
    v_mul_f32 v87, v87, v254
    v_cvt_pk_bf16_f32 v84, v84, v85
    v_cvt_pk_bf16_f32 v85, v86, v87
    buffer_store_dwordx2 v[84:85], v11, s[32:35], s41 offen offset:32
    v_mul_f32 v96, v96, v254
    v_mul_f32 v97, v97, v254
    v_mul_f32 v98, v98, v254
    v_mul_f32 v99, v99, v254
    v_cvt_pk_bf16_f32 v96, v96, v97
    v_cvt_pk_bf16_f32 v97, v98, v99
    buffer_store_dwordx2 v[96:97], v11, s[32:35], s41 offen offset:64
    v_mul_f32 v108, v108, v254
    v_mul_f32 v109, v109, v254
    v_mul_f32 v110, v110, v254
    v_mul_f32 v111, v111, v254
    v_cvt_pk_bf16_f32 v108, v108, v109
    v_cvt_pk_bf16_f32 v109, v110, v111
    buffer_store_dwordx2 v[108:109], v11, s[32:35], s41 offen offset:96
    v_mul_f32 v120, v120, v254
    v_mul_f32 v121, v121, v254
    v_mul_f32 v122, v122, v254
    v_mul_f32 v123, v123, v254
    v_cvt_pk_bf16_f32 v120, v120, v121
    v_cvt_pk_bf16_f32 v121, v122, v123
    buffer_store_dwordx2 v[120:121], v11, s[32:35], s41 offen offset:128
    v_mul_f32 v132, v132, v254
    v_mul_f32 v133, v133, v254
    v_mul_f32 v134, v134, v254
    v_mul_f32 v135, v135, v254
    v_cvt_pk_bf16_f32 v132, v132, v133
    v_cvt_pk_bf16_f32 v133, v134, v135
    buffer_store_dwordx2 v[132:133], v11, s[32:35], s41 offen offset:160
    v_mul_f32 v144, v144, v254
    v_mul_f32 v145, v145, v254
    v_mul_f32 v146, v146, v254
    v_mul_f32 v147, v147, v254
    v_cvt_pk_bf16_f32 v144, v144, v145
    v_cvt_pk_bf16_f32 v145, v146, v147
    buffer_store_dwordx2 v[144:145], v11, s[32:35], s41 offen offset:192
    v_mul_f32 v156, v156, v254
    v_mul_f32 v157, v157, v254
    v_mul_f32 v158, v158, v254
    v_mul_f32 v159, v159, v254
    v_cvt_pk_bf16_f32 v156, v156, v157
    v_cvt_pk_bf16_f32 v157, v158, v159
    buffer_store_dwordx2 v[156:157], v11, s[32:35], s41 offen offset:224
    s_waitcnt vmcnt(0)
attn_done:
    s_endpgm
.globl oproj_kernel
.p2align 8
.type oproj_kernel,@function
oproj_kernel:
    s_cmp_ge_u32 s2, 256
    s_cbranch_scc1 oproj_done
    s_load_dwordx4 s[4:7], s[0:1], 32
    s_load_dwordx2 s[8:9], s[0:1], 56
    v_and_b32 v1, 63, v0
    v_lshrrev_b32 v9, 6, v0
    v_and_b32 v2, 15, v1
    v_lshrrev_b32 v3, 4, v1
    s_nop 0
    v_readfirstlane_b32 s3, v9
    s_and_b32 s10, s2, 7
    s_lshr_b32 s11, s2, 3
    s_lshr_b32 s12, s11, 3
    s_lshl_b32 s13, s10, 2
    s_add_u32 s12, s12, s13
    s_and_b32 s13, s11, 7
    s_waitcnt lgkmcnt(0)
    s_mul_i32 s14, s12, 1179648
    s_add_u32 s16, s8, s14
    s_addc_u32 s17, s9, 0
    s_and_b32 s17, s17, 0xffff
    s_mov_b32 s18, 1179648
    s_mov_b32 s19, 0x20000
    s_lshl_b32 s14, s13, 7
    s_add_u32 s20, s4, s14
    s_addc_u32 s21, s5, 0
    s_and_b32 s21, s21, 0xffff
    s_sub_u32 s22, 0x400000, s14
    s_mov_b32 s23, 0x20000
    s_mul_i32 s15, s12, 147456
    s_add_u32 s15, s15, s14
    s_add_u32 s24, s6, s15
    s_addc_u32 s25, s7, 0
    s_and_b32 s25, s25, 0xffff
    s_sub_u32 s26, 147456, s14
    s_mov_b32 s27, 0x20000
    v_lshrrev_b32 v9, 3, v1
    v_and_b32 v10, 7, v1
    s_and_b32 s30, s3, 1
    s_lshl_b32 s31, s30, 2
    v_or_b32 v11, s31, v3
    v_xor_b32 v11, v11, v10
    v_lshlrev_b32 v4, 13, v9
    v_lshl_add_u32 v4, v11, 4, v4
    v_bfe_u32 v11, v9, 1, 1
    s_lshl_b32 s31, s30, 1
    v_or_b32 v11, s31, v11
    v_lshlrev_b32 v11, 1, v11
    v_xor_b32 v11, v11, v10
    v_lshlrev_b32 v5, 10, v9
    v_lshl_add_u32 v5, v11, 4, v5
    s_lshr_b32 s28, s3, 1
    s_and_b32 s29, s3, 1
    s_mul_i32 s30, s28, 80*128
    v_lshrrev_b32 v9, 1, v2
    v_xor_b32 v9, v9, v3
    v_lshlrev_b32 v6, 7, v2
    v_lshl_add_u32 v6, v9, 4, v6
    v_add_u32 v6, s30, v6
    v_lshrrev_b32 v9, 2, v2
    v_lshl_add_u32 v9, v3, 3, v9
    v_lshlrev_b32 v7, 7, v9
    v_bfe_u32 v10, v2, 3, 1
    v_and_b32 v11, 1, v3
    v_lshl_add_u32 v10, v11, 1, v10
    v_lshlrev_b32 v10, 1, v10
    v_bfe_u32 v11, v2, 1, 1
    v_xor_b32 v10, v10, v11
    s_lshl_b32 s31, s29, 2
    v_xor_b32 v10, s31, v10
    v_lshl_add_u32 v7, v10, 4, v7
    v_and_b32 v9, 1, v2
    v_lshl_add_u32 v7, v9, 3, v7
    v_add_u32 v7, 18432, v7
    s_mul_i32 s30, s28, 80
    v_add_u32 v8, s30, v2
    v_lshlrev_b32 v8, 10, v8
    v_lshl_add_u32 v8, v3, 3, v8
    s_lshl_b32 s30, s29, 6
    v_add_u32 v8, s30, v8
    v_mov_b32 v16, 0
    v_mov_b32 v17, 0
    v_mov_b32 v18, 0
    v_mov_b32 v19, 0
    v_mov_b32 v20, 0
    v_mov_b32 v21, 0
    v_mov_b32 v22, 0
    v_mov_b32 v23, 0
    v_mov_b32 v24, 0
    v_mov_b32 v25, 0
    v_mov_b32 v26, 0
    v_mov_b32 v27, 0
    v_mov_b32 v28, 0
    v_mov_b32 v29, 0
    v_mov_b32 v30, 0
    v_mov_b32 v31, 0
    v_mov_b32 v32, 0
    v_mov_b32 v33, 0
    v_mov_b32 v34, 0
    v_mov_b32 v35, 0
    v_mov_b32 v36, 0
    v_mov_b32 v37, 0
    v_mov_b32 v38, 0
    v_mov_b32 v39, 0
    v_mov_b32 v40, 0
    v_mov_b32 v41, 0
    v_mov_b32 v42, 0
    v_mov_b32 v43, 0
    v_mov_b32 v44, 0
    v_mov_b32 v45, 0
    v_mov_b32 v46, 0
    v_mov_b32 v47, 0
    v_mov_b32 v48, 0
    v_mov_b32 v49, 0
    v_mov_b32 v50, 0
    v_mov_b32 v51, 0
    v_mov_b32 v52, 0
    v_mov_b32 v53, 0
    v_mov_b32 v54, 0
    v_mov_b32 v55, 0
    s_mov_b32 s32, 0
    s_mov_b32 s33, 0
    s_lshl_b32 s34, s3, 10
    s_lshl_b32 s35, s3, 16
    s_add_u32 s36, s34, 0
    s_add_u32 m0, s36, s32
    s_add_u32 s36, s35, 0
    s_add_u32 s36, s36, s33
    buffer_load_dwordx4 v4, s[16:19], s36 offen lds
    s_add_u32 s36, s34, 4096
    s_add_u32 m0, s36, s32
    s_add_u32 s36, s35, 262144
    s_add_u32 s36, s36, s33
    buffer_load_dwordx4 v4, s[16:19], s36 offen lds
    s_add_u32 s36, s34, 8192
    s_add_u32 m0, s36, s32
    s_add_u32 s36, s35, 524288
    s_add_u32 s36, s36, s33
    buffer_load_dwordx4 v4, s[16:19], s36 offen lds
    s_add_u32 s36, s34, 12288
    s_add_u32 m0, s36, s32
    s_add_u32 s36, s35, 786432
    s_add_u32 s36, s36, s33
    buffer_load_dwordx4 v4, s[16:19], s36 offen lds
    s_cmp_ge_u32 s3, 2
    s_cbranch_scc1 oa_skip_p0
    s_add_u32 s36, s34, 16384
    s_add_u32 m0, s36, s32
    s_add_u32 s36, s35, 1048576
    s_add_u32 s36, s36, s33
    buffer_load_dwordx4 v4, s[16:19], s36 offen lds
oa_skip_p0:
    s_lshl_b32 s35, s3, 13
    s_add_u32 s36, s34, 18432
    s_add_u32 m0, s36, s32
    s_lshl_b32 s37, s33, 9
    s_add_u32 s36, s35, 0
    s_add_u32 s36, s36, s37
    buffer_load_dwordx4 v5, s[20:23], s36 offen lds
    s_add_u32 s36, s34, 22528
    s_add_u32 m0, s36, s32
    s_lshl_b32 s37, s33, 9
    s_add_u32 s36, s35, 32768
    s_add_u32 s36, s36, s37
    buffer_load_dwordx4 v5, s[20:23], s36 offen lds
    s_mov_b32 s32, 26624
    s_mov_b32 s33, 128
    s_lshl_b32 s34, s3, 10
    s_lshl_b32 s35, s3, 16
    s_add_u32 s36, s34, 0
    s_add_u32 m0, s36, s32
    s_add_u32 s36, s35, 0
    s_add_u32 s36, s36, s33
    buffer_load_dwordx4 v4, s[16:19], s36 offen lds
    s_add_u32 s36, s34, 4096
    s_add_u32 m0, s36, s32
    s_add_u32 s36, s35, 262144
    s_add_u32 s36, s36, s33
    buffer_load_dwordx4 v4, s[16:19], s36 offen lds
    s_add_u32 s36, s34, 8192
    s_add_u32 m0, s36, s32
    s_add_u32 s36, s35, 524288
    s_add_u32 s36, s36, s33
    buffer_load_dwordx4 v4, s[16:19], s36 offen lds
    s_add_u32 s36, s34, 12288
    s_add_u32 m0, s36, s32
    s_add_u32 s36, s35, 786432
    s_add_u32 s36, s36, s33
    buffer_load_dwordx4 v4, s[16:19], s36 offen lds
    s_cmp_ge_u32 s3, 2
    s_cbranch_scc1 oa_skip_p1
    s_add_u32 s36, s34, 16384
    s_add_u32 m0, s36, s32
    s_add_u32 s36, s35, 1048576
    s_add_u32 s36, s36, s33
    buffer_load_dwordx4 v4, s[16:19], s36 offen lds
oa_skip_p1:
    s_lshl_b32 s35, s3, 13
    s_add_u32 s36, s34, 18432
    s_add_u32 m0, s36, s32
    s_lshl_b32 s37, s33, 9
    s_add_u32 s36, s35, 0
    s_add_u32 s36, s36, s37
    buffer_load_dwordx4 v5, s[20:23], s36 offen lds
    s_add_u32 s36, s34, 22528
    s_add_u32 m0, s36, s32
    s_lshl_b32 s37, s33, 9
    s_add_u32 s36, s35, 32768
    s_add_u32 s36, s36, s37
    buffer_load_dwordx4 v5, s[20:23], s36 offen lds
    s_mov_b32 s32, 53248
    s_mov_b32 s33, 256
    s_lshl_b32 s34, s3, 10
    s_lshl_b32 s35, s3, 16
    s_add_u32 s36, s34, 0
    s_add_u32 m0, s36, s32
    s_add_u32 s36, s35, 0
    s_add_u32 s36, s36, s33
    buffer_load_dwordx4 v4, s[16:19], s36 offen lds
    s_add_u32 s36, s34, 4096
    s_add_u32 m0, s36, s32
    s_add_u32 s36, s35, 262144
    s_add_u32 s36, s36, s33
    buffer_load_dwordx4 v4, s[16:19], s36 offen lds
    s_add_u32 s36, s34, 8192
    s_add_u32 m0, s36, s32
    s_add_u32 s36, s35, 524288
    s_add_u32 s36, s36, s33
    buffer_load_dwordx4 v4, s[16:19], s36 offen lds
    s_add_u32 s36, s34, 12288
    s_add_u32 m0, s36, s32
    s_add_u32 s36, s35, 786432
    s_add_u32 s36, s36, s33
    buffer_load_dwordx4 v4, s[16:19], s36 offen lds
    s_cmp_ge_u32 s3, 2
    s_cbranch_scc1 oa_skip_p2
    s_add_u32 s36, s34, 16384
    s_add_u32 m0, s36, s32
    s_add_u32 s36, s35, 1048576
    s_add_u32 s36, s36, s33
    buffer_load_dwordx4 v4, s[16:19], s36 offen lds
oa_skip_p2:
    s_lshl_b32 s35, s3, 13
    s_add_u32 s36, s34, 18432
    s_add_u32 m0, s36, s32
    s_lshl_b32 s37, s33, 9
    s_add_u32 s36, s35, 0
    s_add_u32 s36, s36, s37
    buffer_load_dwordx4 v5, s[20:23], s36 offen lds
    s_add_u32 s36, s34, 22528
    s_add_u32 m0, s36, s32
    s_lshl_b32 s37, s33, 9
    s_add_u32 s36, s35, 32768
    s_add_u32 s36, s36, s37
    buffer_load_dwordx4 v5, s[20:23], s36 offen lds
    s_mov_b32 s32, 79872
    s_mov_b32 s33, 384
    s_lshl_b32 s34, s3, 10
    s_lshl_b32 s35, s3, 16
    s_add_u32 s36, s34, 0
    s_add_u32 m0, s36, s32
    s_add_u32 s36, s35, 0
    s_add_u32 s36, s36, s33
    buffer_load_dwordx4 v4, s[16:19], s36 offen lds
    s_add_u32 s36, s34, 4096
    s_add_u32 m0, s36, s32
    s_add_u32 s36, s35, 262144
    s_add_u32 s36, s36, s33
    buffer_load_dwordx4 v4, s[16:19], s36 offen lds
    s_add_u32 s36, s34, 8192
    s_add_u32 m0, s36, s32
    s_add_u32 s36, s35, 524288
    s_add_u32 s36, s36, s33
    buffer_load_dwordx4 v4, s[16:19], s36 offen lds
    s_add_u32 s36, s34, 12288
    s_add_u32 m0, s36, s32
    s_add_u32 s36, s35, 786432
    s_add_u32 s36, s36, s33
    buffer_load_dwordx4 v4, s[16:19], s36 offen lds
    s_cmp_ge_u32 s3, 2
    s_cbranch_scc1 oa_skip_p3
    s_add_u32 s36, s34, 16384
    s_add_u32 m0, s36, s32
    s_add_u32 s36, s35, 1048576
    s_add_u32 s36, s36, s33
    buffer_load_dwordx4 v4, s[16:19], s36 offen lds
oa_skip_p3:
    s_lshl_b32 s35, s3, 13
    s_add_u32 s36, s34, 18432
    s_add_u32 m0, s36, s32
    s_lshl_b32 s37, s33, 9
    s_add_u32 s36, s35, 0
    s_add_u32 s36, s36, s37
    buffer_load_dwordx4 v5, s[20:23], s36 offen lds
    s_add_u32 s36, s34, 22528
    s_add_u32 m0, s36, s32
    s_lshl_b32 s37, s33, 9
    s_add_u32 s36, s35, 32768
    s_add_u32 s36, s36, s37
    buffer_load_dwordx4 v5, s[20:23], s36 offen lds
    s_mov_b32 s32, 106496
    s_mov_b32 s33, 512
    s_lshl_b32 s34, s3, 10
    s_lshl_b32 s35, s3, 16
    s_add_u32 s36, s34, 0
    s_add_u32 m0, s36, s32
    s_add_u32 s36, s35, 0
    s_add_u32 s36, s36, s33
    buffer_load_dwordx4 v4, s[16:19], s36 offen lds
    s_add_u32 s36, s34, 4096
    s_add_u32 m0, s36, s32
    s_add_u32 s36, s35, 262144
    s_add_u32 s36, s36, s33
    buffer_load_dwordx4 v4, s[16:19], s36 offen lds
    s_add_u32 s36, s34, 8192
    s_add_u32 m0, s36, s32
    s_add_u32 s36, s35, 524288
    s_add_u32 s36, s36, s33
    buffer_load_dwordx4 v4, s[16:19], s36 offen lds
    s_add_u32 s36, s34, 12288
    s_add_u32 m0, s36, s32
    s_add_u32 s36, s35, 786432
    s_add_u32 s36, s36, s33
    buffer_load_dwordx4 v4, s[16:19], s36 offen lds
    s_cmp_ge_u32 s3, 2
    s_cbranch_scc1 oa_skip_p4
    s_add_u32 s36, s34, 16384
    s_add_u32 m0, s36, s32
    s_add_u32 s36, s35, 1048576
    s_add_u32 s36, s36, s33
    buffer_load_dwordx4 v4, s[16:19], s36 offen lds
oa_skip_p4:
    s_lshl_b32 s35, s3, 13
    s_add_u32 s36, s34, 18432
    s_add_u32 m0, s36, s32
    s_lshl_b32 s37, s33, 9
    s_add_u32 s36, s35, 0
    s_add_u32 s36, s36, s37
    buffer_load_dwordx4 v5, s[20:23], s36 offen lds
    s_add_u32 s36, s34, 22528
    s_add_u32 m0, s36, s32
    s_lshl_b32 s37, s33, 9
    s_add_u32 s36, s35, 32768
    s_add_u32 s36, s36, s37
    buffer_load_dwordx4 v5, s[20:23], s36 offen lds
    s_mov_b32 s40, 0
    s_mov_b32 s41, 0
    s_mov_b32 s42, 133120
oproj_loop:
    s_cmp_ge_u32 s40, 60
    s_cbranch_scc1 oproj_w0
    s_cmp_ge_u32 s3, 2
    s_cbranch_scc1 oproj_w12
    s_waitcnt vmcnt(28)
    s_branch oproj_wd
oproj_w12:
    s_waitcnt vmcnt(24)
    s_branch oproj_wd
oproj_w0:
    s_waitcnt vmcnt(0)
oproj_wd:
    s_barrier
    s_cmp_ge_u32 s40, 59
    s_cbranch_scc1 oproj_noload
    s_add_u32 s33, s40, 5
    s_lshl_b32 s33, s33, 7
    s_lshl_b32 s34, s3, 10
    s_lshl_b32 s35, s3, 16
    s_add_u32 s36, s34, 0
    s_add_u32 m0, s36, s42
    s_add_u32 s36, s35, 0
    s_add_u32 s36, s36, s33
    buffer_load_dwordx4 v4, s[16:19], s36 offen lds
    s_add_u32 s36, s34, 4096
    s_add_u32 m0, s36, s42
    s_add_u32 s36, s35, 262144
    s_add_u32 s36, s36, s33
    buffer_load_dwordx4 v4, s[16:19], s36 offen lds
    s_add_u32 s36, s34, 8192
    s_add_u32 m0, s36, s42
    s_add_u32 s36, s35, 524288
    s_add_u32 s36, s36, s33
    buffer_load_dwordx4 v4, s[16:19], s36 offen lds
    s_add_u32 s36, s34, 12288
    s_add_u32 m0, s36, s42
    s_add_u32 s36, s35, 786432
    s_add_u32 s36, s36, s33
    buffer_load_dwordx4 v4, s[16:19], s36 offen lds
    s_cmp_ge_u32 s3, 2
    s_cbranch_scc1 oa_skip_loop
    s_add_u32 s36, s34, 16384
    s_add_u32 m0, s36, s42
    s_add_u32 s36, s35, 1048576
    s_add_u32 s36, s36, s33
    buffer_load_dwordx4 v4, s[16:19], s36 offen lds
oa_skip_loop:
    s_lshl_b32 s35, s3, 13
    s_add_u32 s36, s34, 18432
    s_add_u32 m0, s36, s42
    s_lshl_b32 s37, s33, 9
    s_add_u32 s36, s35, 0
    s_add_u32 s36, s36, s37
    buffer_load_dwordx4 v5, s[20:23], s36 offen lds
    s_add_u32 s36, s34, 22528
    s_add_u32 m0, s36, s42
    s_lshl_b32 s37, s33, 9
    s_add_u32 s36, s35, 32768
    s_add_u32 s36, s36, s37
    buffer_load_dwordx4 v5, s[20:23], s36 offen lds
oproj_noload:
    v_add_u32 v10, s41, v6
    v_add_u32 v11, s41, v7
    v_xor_b32 v12, 64, v10
    v_xor_b32 v13, 32, v11
    ds_read_b64_tr_b16 v[96:97], v11 offset:0
    ds_read_b64_tr_b16 v[98:99], v11 offset:512
    ds_read_b64_tr_b16 v[100:101], v13 offset:0
    ds_read_b64_tr_b16 v[102:103], v13 offset:512
    ds_read_b128 v[56:59], v10 offset:0
    ds_read_b128 v[60:63], v10 offset:2048
    ds_read_b128 v[64:67], v10 offset:4096
    ds_read_b128 v[68:71], v10 offset:6144
    ds_read_b128 v[72:75], v10 offset:8192
    ds_read_b64_tr_b16 v[104:105], v11 offset:4096
    ds_read_b64_tr_b16 v[106:107], v11 offset:4608
    ds_read_b64_tr_b16 v[108:109], v13 offset:4096
    ds_read_b64_tr_b16 v[110:111], v13 offset:4608
    ds_read_b128 v[76:79], v12 offset:0
    ds_read_b128 v[80:83], v12 offset:2048
    ds_read_b128 v[84:87], v12 offset:4096
    ds_read_b128 v[88:91], v12 offset:6144
    ds_read_b128 v[92:95], v12 offset:8192
    s_waitcnt lgkmcnt(13)
    v_mfma_f32_16x16x32_bf16 v[16:19], v[96:99], v[56:59], v[16:19]
    v_mfma_f32_16x16x32_bf16 v[20:23], v[100:103], v[56:59], v[20:23]
    s_waitcnt lgkmcnt(12)
    v_mfma_f32_16x16x32_bf16 v[24:27], v[96:99], v[60:63], v[24:27]
    v_mfma_f32_16x16x32_bf16 v[28:31], v[100:103], v[60:63], v[28:31]
    s_waitcnt lgkmcnt(11)
    v_mfma_f32_16x16x32_bf16 v[32:35], v[96:99], v[64:67], v[32:35]
    v_mfma_f32_16x16x32_bf16 v[36:39], v[100:103], v[64:67], v[36:39]
    s_waitcnt lgkmcnt(10)
    v_mfma_f32_16x16x32_bf16 v[40:43], v[96:99], v[68:71], v[40:43]
    v_mfma_f32_16x16x32_bf16 v[44:47], v[100:103], v[68:71], v[44:47]
    s_waitcnt lgkmcnt(9)
    v_mfma_f32_16x16x32_bf16 v[48:51], v[96:99], v[72:75], v[48:51]
    v_mfma_f32_16x16x32_bf16 v[52:55], v[100:103], v[72:75], v[52:55]
    s_waitcnt lgkmcnt(4)
    v_mfma_f32_16x16x32_bf16 v[16:19], v[104:107], v[76:79], v[16:19]
    v_mfma_f32_16x16x32_bf16 v[20:23], v[108:111], v[76:79], v[20:23]
    s_waitcnt lgkmcnt(3)
    v_mfma_f32_16x16x32_bf16 v[24:27], v[104:107], v[80:83], v[24:27]
    v_mfma_f32_16x16x32_bf16 v[28:31], v[108:111], v[80:83], v[28:31]
    s_waitcnt lgkmcnt(2)
    v_mfma_f32_16x16x32_bf16 v[32:35], v[104:107], v[84:87], v[32:35]
    v_mfma_f32_16x16x32_bf16 v[36:39], v[108:111], v[84:87], v[36:39]
    s_waitcnt lgkmcnt(1)
    v_mfma_f32_16x16x32_bf16 v[40:43], v[104:107], v[88:91], v[40:43]
    v_mfma_f32_16x16x32_bf16 v[44:47], v[108:111], v[88:91], v[44:47]
    s_waitcnt lgkmcnt(0)
    v_mfma_f32_16x16x32_bf16 v[48:51], v[104:107], v[92:95], v[48:51]
    v_mfma_f32_16x16x32_bf16 v[52:55], v[108:111], v[92:95], v[52:55]
    s_add_u32 s41, s41, 26624
    s_cmp_ge_u32 s41, 159744
    s_cselect_b32 s41, 0, s41
    s_add_u32 s42, s42, 26624
    s_cmp_ge_u32 s42, 159744
    s_cselect_b32 s42, 0, s42
    s_add_u32 s40, s40, 1
    s_cmp_lt_u32 s40, 64
    s_cbranch_scc1 oproj_loop
    s_nop 9
    s_mov_b32 s36, 0
    v_cvt_pk_bf16_f32 v16, v16, v17
    v_cvt_pk_bf16_f32 v17, v18, v19
    buffer_store_dwordx2 v[16:17], v8, s[24:27], s36 offen offset:0
    v_cvt_pk_bf16_f32 v20, v20, v21
    v_cvt_pk_bf16_f32 v21, v22, v23
    buffer_store_dwordx2 v[20:21], v8, s[24:27], s36 offen offset:32
    s_mov_b32 s36, 16384
    v_cvt_pk_bf16_f32 v24, v24, v25
    v_cvt_pk_bf16_f32 v25, v26, v27
    buffer_store_dwordx2 v[24:25], v8, s[24:27], s36 offen offset:0
    v_cvt_pk_bf16_f32 v28, v28, v29
    v_cvt_pk_bf16_f32 v29, v30, v31
    buffer_store_dwordx2 v[28:29], v8, s[24:27], s36 offen offset:32
    s_mov_b32 s36, 32768
    v_cvt_pk_bf16_f32 v32, v32, v33
    v_cvt_pk_bf16_f32 v33, v34, v35
    buffer_store_dwordx2 v[32:33], v8, s[24:27], s36 offen offset:0
    v_cvt_pk_bf16_f32 v36, v36, v37
    v_cvt_pk_bf16_f32 v37, v38, v39
    buffer_store_dwordx2 v[36:37], v8, s[24:27], s36 offen offset:32
    s_mov_b32 s36, 49152
    v_cvt_pk_bf16_f32 v40, v40, v41
    v_cvt_pk_bf16_f32 v41, v42, v43
    buffer_store_dwordx2 v[40:41], v8, s[24:27], s36 offen offset:0
    v_cvt_pk_bf16_f32 v44, v44, v45
    v_cvt_pk_bf16_f32 v45, v46, v47
    buffer_store_dwordx2 v[44:45], v8, s[24:27], s36 offen offset:32
    s_cmp_eq_u32 s28, 1
    s_cbranch_scc1 oproj_end
    s_mov_b32 s36, 65536
    v_cvt_pk_bf16_f32 v48, v48, v49
    v_cvt_pk_bf16_f32 v49, v50, v51
    buffer_store_dwordx2 v[48:49], v8, s[24:27], s36 offen offset:0
    v_cvt_pk_bf16_f32 v52, v52, v53
    v_cvt_pk_bf16_f32 v53, v54, v55
    buffer_store_dwordx2 v[52:53], v8, s[24:27], s36 offen offset:32
oproj_end:
    s_waitcnt vmcnt(0)
oproj_done:
    s_endpgm
.section .rodata,"a"
.p2align 6
.amdhsa_kernel attn_kernel
  .amdhsa_next_free_vgpr 256
  .amdhsa_next_free_sgpr 96
  .amdhsa_accum_offset 256
  .amdhsa_group_segment_fixed_size 0
  .amdhsa_kernarg_size 64
  .amdhsa_user_sgpr_count 2
  .amdhsa_user_sgpr_kernarg_segment_ptr 1
  .amdhsa_system_sgpr_workgroup_id_x 1
.end_amdhsa_kernel
.p2align 6
.amdhsa_kernel oproj_kernel
  .amdhsa_next_free_vgpr 112
  .amdhsa_next_free_sgpr 96
  .amdhsa_accum_offset 112
  .amdhsa_group_segment_fixed_size 0
  .amdhsa_kernarg_size 64
  .amdhsa_user_sgpr_count 2
  .amdhsa_user_sgpr_kernarg_segment_ptr 1
  .amdhsa_system_sgpr_workgroup_id_x 1
.end_amdhsa_kernel
```
